```python
import torch

def _softmax(x, axis=-1):
    return torch.softmax(x, dim=axis)

def _gelu(x):
    return torch.nn.functional.gelu(x, approximate='tanh')

def _silu(x):
    return torch.nn.functional.silu(x)

def _sigmoid(x):
    return torch.sigmoid(x)

def _layernorm(x, axis=-1, eps=1e-05):
    m = x.mean(dim=axis, keepdim=True)
    v = x.var(dim=axis, keepdim=True, unbiased=False)
    return (x - m) / torch.sqrt(v + eps)

def _scatter_add(tgt, idx, src, axis=0):
    return tgt.clone().index_add_(axis, idx, src)

def _segment_sum(src, seg, n):
    out = torch.zeros((n,) + src.shape[1:], dtype=src.dtype)
    return out.index_add_(0, seg, src)

def _pad(x, pw):
    flat = tuple((v for pair in reversed(pw) for v in pair))
    return torch.nn.functional.pad(x, flat)
kernel_name = 'adaLN_cond__gqa_block_cached__glu_gated_geglu__decode'

def setup_inputs():

    _w = lambda a: (lambda t: t.to(torch.bfloat16) if t.is_floating_point() else t)(torch.as_tensor(a))

    def _A_setup():
        B, Sq, D = (1, 1, 640)
        Hq, Hkv, Sk, Dh = (32, 32, 4096, 128)
        assert Hq % Hkv == 0, (Hq, Hkv)
        return {'x': _w((lambda *s: torch.randn(*s, dtype=torch.bfloat16) * 0.05)(B, Sq, D)), 'k_cache': _w((lambda *s: torch.randn(*s, dtype=torch.bfloat16) * 3.2)(B, Hkv, Sk, Dh)), 'v_cache': _w((lambda *s: torch.randn(*s, dtype=torch.bfloat16) * 3.2)(B, Hkv, Sk, Dh)), 'wq': _w((lambda *s: torch.randn(*s, dtype=torch.bfloat16) * 3.2)(D, Hq * Dh) * D ** (-0.5)), 'wo': _w((lambda *s: torch.randn(*s, dtype=torch.bfloat16) * 3.2)(Hq * Dh, D) * (Hq * Dh) ** (-0.5))}
    _A_in = _A_setup()

    def _B_setup():
        B, S, Dm, Df = (1, 1, 640, 1728)
        return {'x': _w((lambda *s: torch.randn(*s, dtype=torch.bfloat16) * 0.05)(B, S, Dm)), 'w_gate': _w((lambda *s: torch.randn(*s, dtype=torch.bfloat16) * 3.2)(Dm, Df) * Dm ** (-0.5)), 'w_up': _w((lambda *s: torch.randn(*s, dtype=torch.bfloat16) * 3.2)(Dm, Df) * Dm ** (-0.5)), 'w_down': _w((lambda *s: torch.randn(*s, dtype=torch.bfloat16) * 3.2)(Df, Dm) * Df ** (-0.5))}
    _B_in = _B_setup()
    return {'A_x': _A_in['x'], 'A_k_cache': _A_in['k_cache'], 'A_v_cache': _A_in['v_cache'], 'A_wq': _A_in['wq'], 'A_wo': _A_in['wo'], 'B_x': _B_in['x'], 'B_w_gate': _B_in['w_gate'], 'B_w_up': _B_in['w_up'], 'B_w_down': _B_in['w_down'], 'c': _w((lambda *s: torch.randn(*s, dtype=torch.bfloat16) * 0.1)(1, 640) * 8.0), 'w_mod': _w((lambda *s: torch.randn(*s, dtype=torch.bfloat16) * 0.1)(640, 6 * 640) * 640 ** (-0.5) * 8.0)}

def reference(A_x, A_k_cache, A_v_cache, A_wq, A_wo, B_x, B_w_gate, B_w_up, B_w_down, c, w_mod):

    def _A_ref(x, k_cache, v_cache, wq, wo):
        B, Sq, D = x.shape
        Hq, Dh = (32, 128)
        Hkv = k_cache.shape[1]
        rep = Hq // Hkv
        q = (lambda x, *d: x.permute(*d))((x @ wq).reshape(B, Sq, Hq, Dh), 0, 2, 1, 3)
        k = (lambda x, n, axis: torch.repeat_interleave(x, n, dim=axis))(k_cache, rep, axis=1)
        v = (lambda x, n, axis: torch.repeat_interleave(x, n, dim=axis))(v_cache, rep, axis=1)
        scores = torch.einsum('bhqd,bhkd->bhqk', q, k) * Dh ** (-0.5)
        p = _softmax(scores, axis=-1)
        o = torch.einsum('bhqk,bhkd->bhqd', p, v)
        return (lambda x, *d: x.permute(*d))(o, 0, 2, 1, 3).reshape(B, Sq, Hq * Dh) @ wo

    def _B_ref(x, w_gate, w_up, w_down):
        g = torch.einsum('bsd,df->bsf', x, w_gate)
        u = torch.einsum('bsd,df->bsf', x, w_up)
        h = _gelu(g) * u
        return torch.einsum('bsf,fd->bsd', h, w_down)
    x = A_x
    mod = (_silu(c) @ w_mod).reshape(c.shape[0], 6, 1, -1)
    sa, ca, ga, sb, cb, gb = (mod[:, 0].clone(), mod[:, 1].clone(), mod[:, 2].clone(), mod[:, 3].clone(), mod[:, 4].clone(), mod[:, 5].clone())
    h = _layernorm(x, axis=-1) * (1 + ca) + sa
    x = x + ga * _A_ref(h, A_k_cache, A_v_cache, A_wq, A_wo)
    h = _layernorm(x, axis=-1) * (1 + cb) + sb
    x = x + gb * _B_ref(h, B_w_gate, B_w_up, B_w_down)
    return x
```

```asm
; @launch grid=(256,1,1) block=(512,1,1) lds=147456
.amdgcn_target "amdgcn-amd-amdhsa--gfx950"
.text
.globl adaLN_cond__gqa_block_cached__glu_gated_geglu__decode_kernel
.p2align 8
.type adaLN_cond__gqa_block_cached__glu_gated_geglu__decode_kernel,@function
adaLN_cond__gqa_block_cached__glu_gated_geglu__decode_kernel:

    s_cmp_ge_u32 s2, 256
    s_cbranch_scc1 L_end
    s_load_dwordx16 s[16:31], s[0:1], 0
    s_load_dwordx8 s[32:39], s[0:1], 64
    s_load_dwordx4 s[40:43], s[0:1], 96
    v_lshrrev_b32 v1, 6, v0
    v_and_b32 v0, 63, v0
    v_readfirstlane_b32 s3, v1
    s_and_b32 s4, s2, 7
    s_lshr_b32 s5, s2, 3
    s_lshr_b32 s6, s5, 3
    s_lshl_b32 s60, s4, 2
    s_add_u32 s6, s6, s60
    s_and_b32 s7, s5, 7
    s_mov_b32 s12, 0x05040100
    s_mov_b32 s13, 0x07060302
    v_mov_b32 v14, 131072
    v_mov_b32 v15, 1
    s_cmp_ge_u32 s3, 4
    s_cbranch_scc1 L_aux
    v_lshrrev_b32 v4, 4, v0
    v_and_b32 v5, 15, v0
    s_lshl_b32 s60, s3, 2
    v_add_u32 v6, s60, v4
    v_xor_b32 v2, v5, v6
    v_lshlrev_b32 v2, 4, v2
    v_lshl_add_u32 v2, v4, 8, v2
    v_lshlrev_b32 v3, 4, v0
    s_lshl_b32 s62, s6, 20
    s_lshl_b32 s60, s7, 17
    s_add_u32 s62, s62, s60
    s_lshl_b32 s60, s3, 10
    s_add_u32 s62, s62, s60
    s_mov_b32 m0, s60
    s_mov_b32 s63, s62
    s_waitcnt lgkmcnt(0)
    s_mov_b32 s48, s18
    s_mov_b32 s49, s19
    s_mov_b32 s50, 33554432
    s_mov_b32 s51, 0x20000
    s_mov_b32 s61, 0
L_k1:
    buffer_load_dwordx4 v2, s[48:51], s62 offen nt lds
    s_addk_i32 s62, 0x1000
    s_addk_i32 m0, 0x1000
    s_add_u32 s61, s61, 1
    s_cmp_lt_u32 s61, 2
    s_cbranch_scc1 L_k1
    s_barrier
    s_branch L_stream2
L_aux:
    s_setprio 3
    s_sub_u32 s8, s3, 4
    v_lshlrev_b32 v6, 2, v0
    s_cmp_lg_u32 s8, 0
    s_cbranch_scc1 L_noinit
    v_add_u32 v16, v14, v6
    v_mov_b32 v17, 0
    ds_write_b32 v16, v17
L_noinit:
    s_mul_i32 s67, s2, 205
    s_lshr_b32 s67, s67, 12
    s_mul_i32 s60, s67, 20
    s_sub_u32 s66, s2, s60
    s_cmp_lt_u32 s2, 80
    s_cbranch_scc1 L_unit
    s_sub_u32 s61, s2, 80
    s_mul_i32 s67, s61, 205
    s_lshr_b32 s67, s67, 13
    s_mul_i32 s60, s67, 40
    s_sub_u32 s66, s61, s60
    s_add_u32 s66, s66, 20
L_unit:
    s_mul_i32 s68, s67, 160
    s_mul_i32 s60, s8, 40
    s_add_u32 s68, s68, s60
    s_mul_i32 s69, s68, 7680
    s_lshl_b32 s60, s66, 7
    s_add_u32 s69, s69, s60
    s_lshl_b32 s68, s68, 1
    v_lshrrev_b32 v3, 3, v0
    v_mul_u32_u24 v5, 7680, v3
    v_and_b32 v4, 7, v0
    v_lshl_add_u32 v5, v4, 4, v5
    v_lshlrev_b32 v3, 1, v3
    s_mul_i32 s70, s7, 80
    s_mul_i32 s61, s8, 20
    s_add_u32 s70, s70, s61
    s_lshl_b32 s71, s70, 13
    s_lshl_b32 s61, s6, 8
    s_add_u32 s71, s71, s61
    s_waitcnt lgkmcnt(0)
    s_load_dword s9, s[42:43], 0
    s_mov_b32 s44, s42
    s_mov_b32 s45, s43
    s_mov_b32 s46, 268435456
    s_mov_b32 s47, 0x20000
    s_cmp_ge_u32 s2, 240
    s_cbranch_scc1 L_noprod
    s_mov_b32 s52, s36
    s_mov_b32 s53, s37
    s_mov_b32 s54, 4915200
    s_mov_b32 s55, 0x20000
    s_mov_b32 s48, s34
    s_mov_b32 s49, s35
    s_mov_b32 s50, 1280
    s_mov_b32 s51, 0x20000
    buffer_load_dwordx4 v[96:99], v5, s[52:55], s69 offen nt
    s_add_u32 s69, s69, 61440
    buffer_load_dwordx4 v[100:103], v5, s[52:55], s69 offen nt
    s_add_u32 s69, s69, 61440
    buffer_load_dwordx4 v[104:107], v5, s[52:55], s69 offen nt
    s_add_u32 s69, s69, 61440
    buffer_load_dwordx4 v[108:111], v5, s[52:55], s69 offen nt
    s_add_u32 s69, s69, 61440
    buffer_load_dwordx4 v[112:115], v5, s[52:55], s69 offen nt
    buffer_load_ushort v160, v3, s[48:51], s68 offen offset:0
    buffer_load_ushort v161, v3, s[48:51], s68 offen offset:16
    buffer_load_ushort v162, v3, s[48:51], s68 offen offset:32
    buffer_load_ushort v163, v3, s[48:51], s68 offen offset:48
    buffer_load_ushort v164, v3, s[48:51], s68 offen offset:64
L_noprod:
    s_barrier
    s_mov_b32 s52, s22
    s_mov_b32 s53, s23
    s_mov_b32 s54, 5242880
    s_mov_b32 s55, 0x20000
    s_mov_b32 s48, s16
    s_mov_b32 s49, s17
    s_mov_b32 s50, 1280
    s_mov_b32 s51, 0x20000
    buffer_load_dword v136, v6, s[52:55], s71 offen nt
    s_addk_i32 s71, 0x2000
    buffer_load_dword v137, v6, s[52:55], s71 offen nt
    s_addk_i32 s71, 0x2000
    buffer_load_dword v138, v6, s[52:55], s71 offen nt
    s_addk_i32 s71, 0x2000
    buffer_load_dword v139, v6, s[52:55], s71 offen nt
    s_addk_i32 s71, 0x2000
    buffer_load_dword v140, v6, s[52:55], s71 offen nt
    s_addk_i32 s71, 0x2000
    buffer_load_dword v141, v6, s[52:55], s71 offen nt
    s_addk_i32 s71, 0x2000
    buffer_load_dword v142, v6, s[52:55], s71 offen nt
    s_addk_i32 s71, 0x2000
    buffer_load_dword v143, v6, s[52:55], s71 offen nt
    s_addk_i32 s71, 0x2000
    buffer_load_dword v144, v6, s[52:55], s71 offen nt
    s_addk_i32 s71, 0x2000
    buffer_load_dword v145, v6, s[52:55], s71 offen nt
    s_addk_i32 s71, 0x2000
    buffer_load_dword v146, v6, s[52:55], s71 offen nt
    s_addk_i32 s71, 0x2000
    buffer_load_dword v147, v6, s[52:55], s71 offen nt
    s_addk_i32 s71, 0x2000
    buffer_load_dword v148, v6, s[52:55], s71 offen nt
    s_addk_i32 s71, 0x2000
    buffer_load_dword v149, v6, s[52:55], s71 offen nt
    s_addk_i32 s71, 0x2000
    buffer_load_dword v150, v6, s[52:55], s71 offen nt
    s_addk_i32 s71, 0x2000
    buffer_load_dword v151, v6, s[52:55], s71 offen nt
    s_addk_i32 s71, 0x2000
    buffer_load_dword v152, v6, s[52:55], s71 offen nt
    s_addk_i32 s71, 0x2000
    buffer_load_dword v153, v6, s[52:55], s71 offen nt
    s_addk_i32 s71, 0x2000
    buffer_load_dword v154, v6, s[52:55], s71 offen nt
    s_addk_i32 s71, 0x2000
    buffer_load_dword v155, v6, s[52:55], s71 offen nt
    v_lshrrev_b32 v16, 4, v0
    v_and_b32 v17, 15, v0
    v_min_u32 v17, 9, v17
    v_mul_u32_u24 v4, 20, v0
    s_lshl_b32 s61, s70, 1
    v_lshlrev_b32 v5, 2, v17
    buffer_load_dwordx4 v[166:169], v4, s[48:51], 0 offen
    buffer_load_dword v170, v4, s[48:51], 0 offen offset:16
    buffer_load_dword v171, v5, s[48:51], s61 offen
    s_waitcnt lgkmcnt(0)
    s_add_u32 s9, s9, 1640531527
    s_mov_b32 s98, 0xff
    v_mov_b32 v18, s9
    v_mov_b32 v2, 0
    v_mov_b32 v7, 0
    v_mov_b32 v8, 0
    v_mov_b32 v9, 0
    v_mov_b32 v10, 0
    v_mov_b32 v11, 0
    v_mov_b32 v12, 0
    v_mov_b32 v13, 0
    v_mov_b32 v157, 0
    v_mov_b32 v158, 0
    v_mov_b32 v159, 0
    s_mov_b32 s10, 0
    s_sub_u32 s11, s2, 160
    s_cmp_lt_u32 s11, 40
    s_cselect_b32 s10, 3, 0
    s_mov_b32 s95, 0
    s_mov_b32 s92, 0
    s_mov_b32 s93, 0
    s_mov_b32 s94, 0
L_roled:
L_fdry_ret:
    s_mov_b64 exec, -1
L_front:
    s_cmp_ge_u32 s2, 240
    s_cbranch_scc1 L_ln1
    s_cbranch_execz wv_16
    s_waitcnt vmcnt(23)
wv_16:
    v_lshlrev_b32 v160, 16, v160
    v_mul_f32 v44, 0xbfb8aa3b, v160
    v_exp_f32 v44, v44
    v_lshlrev_b32 v161, 16, v161
    v_mul_f32 v45, 0xbfb8aa3b, v161
    v_exp_f32 v45, v45
    v_lshlrev_b32 v162, 16, v162
    v_mul_f32 v46, 0xbfb8aa3b, v162
    v_exp_f32 v46, v46
    v_lshlrev_b32 v163, 16, v163
    v_mul_f32 v47, 0xbfb8aa3b, v163
    v_exp_f32 v47, v47
    v_lshlrev_b32 v164, 16, v164
    v_mul_f32 v48, 0xbfb8aa3b, v164
    v_exp_f32 v48, v48
    v_add_f32 v44, 1.0, v44
    v_rcp_f32 v44, v44
    v_add_f32 v45, 1.0, v45
    v_rcp_f32 v45, v45
    v_add_f32 v46, 1.0, v46
    v_rcp_f32 v46, v46
    v_add_f32 v47, 1.0, v47
    v_rcp_f32 v47, v47
    v_add_f32 v48, 1.0, v48
    v_rcp_f32 v48, v48
    v_mul_f32 v44, v160, v44
    v_mul_f32 v45, v161, v45
    v_mul_f32 v46, v162, v46
    v_mul_f32 v47, v163, v47
    v_mul_f32 v48, v164, v48
    v_cvt_pk_bf16_f32 v36, v44, v45
    v_cvt_pk_bf16_f32 v37, v46, v47
    v_cvt_pk_bf16_f32 v38, v48, 0
    v_mov_b32 v48, 0
    v_mov_b32 v49, 0
    v_mov_b32 v50, 0
    v_mov_b32 v51, 0
    v_mov_b32 v52, 0
    v_mov_b32 v53, 0
    v_mov_b32 v54, 0
    v_mov_b32 v55, 0
    v_perm_b32 v44, v100, v96, s12
    v_perm_b32 v100, v100, v96, s13
    v_perm_b32 v45, v101, v97, s12
    v_perm_b32 v101, v101, v97, s13
    v_perm_b32 v46, v102, v98, s12
    v_perm_b32 v102, v102, v98, s13
    v_perm_b32 v47, v103, v99, s12
    v_perm_b32 v103, v103, v99, s13
    v_dot2c_f32_bf16 v48, v44, v36
    v_dot2c_f32_bf16 v49, v100, v36
    v_dot2c_f32_bf16 v50, v45, v36
    v_dot2c_f32_bf16 v51, v101, v36
    v_dot2c_f32_bf16 v52, v46, v36
    v_dot2c_f32_bf16 v53, v102, v36
    v_dot2c_f32_bf16 v54, v47, v36
    v_dot2c_f32_bf16 v55, v103, v36
    v_perm_b32 v96, v108, v104, s12
    v_perm_b32 v108, v108, v104, s13
    v_perm_b32 v97, v109, v105, s12
    v_perm_b32 v109, v109, v105, s13
    v_perm_b32 v98, v110, v106, s12
    v_perm_b32 v110, v110, v106, s13
    v_perm_b32 v99, v111, v107, s12
    v_perm_b32 v111, v111, v107, s13
    v_dot2c_f32_bf16 v48, v96, v37
    v_dot2c_f32_bf16 v49, v108, v37
    v_dot2c_f32_bf16 v50, v97, v37
    v_dot2c_f32_bf16 v51, v109, v37
    v_dot2c_f32_bf16 v52, v98, v37
    v_dot2c_f32_bf16 v53, v110, v37
    v_dot2c_f32_bf16 v54, v99, v37
    v_dot2c_f32_bf16 v55, v111, v37
    v_and_b32 v104, 0xffff, v112
    v_lshrrev_b32 v112, 16, v112
    v_dot2c_f32_bf16 v48, v104, v38
    v_dot2c_f32_bf16 v49, v112, v38
    v_and_b32 v105, 0xffff, v113
    v_lshrrev_b32 v113, 16, v113
    v_dot2c_f32_bf16 v50, v105, v38
    v_dot2c_f32_bf16 v51, v113, v38
    v_and_b32 v106, 0xffff, v114
    v_lshrrev_b32 v114, 16, v114
    v_dot2c_f32_bf16 v52, v106, v38
    v_dot2c_f32_bf16 v53, v114, v38
    v_and_b32 v107, 0xffff, v115
    v_lshrrev_b32 v115, 16, v115
    v_dot2c_f32_bf16 v54, v107, v38
    v_dot2c_f32_bf16 v55, v115, v38
    v_permlane32_swap_b32 v48, v52
    v_permlane32_swap_b32 v49, v53
    v_permlane32_swap_b32 v50, v54
    v_permlane32_swap_b32 v51, v55
    v_add_f32 v48, v48, v52
    v_add_f32 v49, v49, v53
    v_add_f32 v50, v50, v54
    v_add_f32 v51, v51, v55
    s_nop 0
    v_permlane16_swap_b32 v48, v50
    v_permlane16_swap_b32 v49, v51
    v_add_f32 v48, v48, v50
    v_add_f32 v49, v49, v51
    s_nop 0
    v_add_f32_dpp v48, v48, v48 row_ror:8 row_mask:0xf bank_mask:0xf
    v_add_f32_dpp v49, v49, v49 row_ror:8 row_mask:0xf bank_mask:0xf
    s_lshl_b32 s60, s8, 8
    s_add_u32 s60, s60, 131328
    v_and_b32 v3, 7, v0
    v_lshlrev_b32 v2, 5, v3
    v_lshl_add_u32 v2, v16, 3, v2
    v_add_u32 v2, s60, v2
    ds_write_b64 v2, v[48:49]
    s_mov_b64 s[14:15], exec
    s_and_b32 exec_lo, exec_lo, 1
    s_mov_b32 exec_hi, 0
    ds_add_rtn_u32 v44, v14, v15 offset:0
    s_mov_b64 exec, s[14:15]
    s_waitcnt lgkmcnt(0)
    s_cbranch_execz la_17
    v_readfirstlane_b32 s60, v44
    s_cmp_lg_u32 s60, 3
    s_cbranch_scc1 L_ln1
la_17:
    v_lshlrev_b32 v3, 3, v0
    v_add_u32 v3, 131328, v3
    v_lshlrev_b32 v2, 4, v0
    s_mov_b64 s[14:15], exec
    s_mov_b32 exec_hi, 0
    ds_read_b64 v[44:45], v3 offset:0
    ds_read_b64 v[46:47], v3 offset:256
    ds_read_b64 v[48:49], v3 offset:512
    ds_read_b64 v[50:51], v3 offset:768
    s_mul_i32 s67, s2, 205
    s_lshr_b32 s67, s67, 12
    s_mul_i32 s60, s67, 20
    s_sub_u32 s66, s2, s60
    s_cmp_lt_u32 s2, 80
    s_cbranch_scc1 L_unit2
    s_sub_u32 s61, s2, 80
    s_mul_i32 s67, s61, 205
    s_lshr_b32 s67, s67, 13
    s_mul_i32 s60, s67, 40
    s_sub_u32 s66, s61, s60
    s_add_u32 s66, s66, 20
L_unit2:
    s_mul_i32 s60, s67, 30720
    s_lshl_b32 s61, s66, 9
    s_add_u32 s60, s60, s61
    s_add_u32 s60, s60, 1048576
    s_waitcnt lgkmcnt(0)
    v_pk_add_f32 v[44:45], v[44:45], v[46:47]
    v_pk_add_f32 v[48:49], v[48:49], v[50:51]
    v_pk_add_f32 v[44:45], v[44:45], v[48:49]
    v_mov_b32 v46, v45
    v_mov_b32 v45, s9
    v_mov_b32 v47, s9
    v_mov_b32 v4, 0
    s_cbranch_execz L_sks376
    buffer_store_dwordx4 v[44:47], v2, s[44:47], s60 offen sc1
L_sks376:
    s_mov_b64 exec, s[14:15]
L_ln1:
    s_cbranch_execz wv_18
    s_waitcnt vmcnt(2)
wv_18:
    s_nop 0
    v_perm_b32 v64, v137, v136, s12
    v_perm_b32 v137, v137, v136, s13
    v_perm_b32 v136, v139, v138, s12
    v_perm_b32 v139, v139, v138, s13
    v_perm_b32 v138, v141, v140, s12
    v_perm_b32 v141, v141, v140, s13
    v_perm_b32 v140, v143, v142, s12
    v_perm_b32 v143, v143, v142, s13
    v_perm_b32 v142, v145, v144, s12
    v_perm_b32 v145, v145, v144, s13
    v_perm_b32 v144, v147, v146, s12
    v_perm_b32 v147, v147, v146, s13
    v_perm_b32 v146, v149, v148, s12
    v_perm_b32 v149, v149, v148, s13
    v_perm_b32 v148, v151, v150, s12
    v_perm_b32 v151, v151, v150, s13
    v_perm_b32 v150, v153, v152, s12
    v_perm_b32 v153, v153, v152, s13
    v_perm_b32 v152, v155, v154, s12
    v_perm_b32 v155, v155, v154, s13
    s_cbranch_execz wv_19
    s_waitcnt vmcnt(0)
wv_19:
    v_lshlrev_b32 v48, 16, v166
    v_and_b32 v49, 0xffff0000, v166
    v_lshlrev_b32 v50, 16, v167
    v_and_b32 v51, 0xffff0000, v167
    v_lshlrev_b32 v52, 16, v168
    v_and_b32 v53, 0xffff0000, v168
    v_lshlrev_b32 v54, 16, v169
    v_and_b32 v55, 0xffff0000, v169
    v_lshlrev_b32 v56, 16, v170
    v_and_b32 v57, 0xffff0000, v170
    v_add_f32 v58, v48, v49
    v_add_f32 v58, v58, v50
    v_add_f32 v58, v58, v51
    v_add_f32 v58, v58, v52
    v_add_f32 v58, v58, v53
    v_add_f32 v58, v58, v54
    v_add_f32 v58, v58, v55
    v_add_f32 v58, v58, v56
    v_add_f32 v58, v58, v57
    s_nop 1
    v_add_f32_dpp v58, v58, v58 quad_perm:[1,0,3,2] row_mask:0xf bank_mask:0xf
    s_nop 1
    v_add_f32_dpp v58, v58, v58 quad_perm:[2,3,0,1] row_mask:0xf bank_mask:0xf
    s_nop 1
    v_add_f32_dpp v58, v58, v58 row_half_mirror row_mask:0xf bank_mask:0xf
    s_nop 1
    v_add_f32_dpp v58, v58, v58 row_mirror row_mask:0xf bank_mask:0xf
    v_mov_b32 v59, v58
    s_nop 1
    v_permlane16_swap_b32 v59, v58
    v_add_f32 v58, v58, v59
    v_mov_b32 v59, v58
    s_nop 1
    v_permlane32_swap_b32 v59, v58
    v_add_f32 v58, v58, v59
    v_mul_f32 v58, 0x3acccccd, v58
    v_mov_b32 v60, 0
    v_sub_f32 v48, v48, v58
    v_fmac_f32 v60, v48, v48
    v_sub_f32 v49, v49, v58
    v_fmac_f32 v60, v49, v49
    v_sub_f32 v50, v50, v58
    v_fmac_f32 v60, v50, v50
    v_sub_f32 v51, v51, v58
    v_fmac_f32 v60, v51, v51
    v_sub_f32 v52, v52, v58
    v_fmac_f32 v60, v52, v52
    v_sub_f32 v53, v53, v58
    v_fmac_f32 v60, v53, v53
    v_sub_f32 v54, v54, v58
    v_fmac_f32 v60, v54, v54
    v_sub_f32 v55, v55, v58
    v_fmac_f32 v60, v55, v55
    v_sub_f32 v56, v56, v58
    v_fmac_f32 v60, v56, v56
    v_sub_f32 v57, v57, v58
    v_fmac_f32 v60, v57, v57
    s_nop 1
    v_add_f32_dpp v60, v60, v60 quad_perm:[1,0,3,2] row_mask:0xf bank_mask:0xf
    s_nop 1
    v_add_f32_dpp v60, v60, v60 quad_perm:[2,3,0,1] row_mask:0xf bank_mask:0xf
    s_nop 1
    v_add_f32_dpp v60, v60, v60 row_half_mirror row_mask:0xf bank_mask:0xf
    s_nop 1
    v_add_f32_dpp v60, v60, v60 row_mirror row_mask:0xf bank_mask:0xf
    v_mov_b32 v59, v60
    s_nop 1
    v_permlane16_swap_b32 v59, v60
    v_add_f32 v60, v60, v59
    v_mov_b32 v59, v60
    s_nop 1
    v_permlane32_swap_b32 v59, v60
    v_add_f32 v60, v60, v59
    v_mul_f32 v60, 0x3acccccd, v60
    v_cvt_pk_bf16_f32 v59, v58, v60
    v_lshlrev_b32 v58, 16, v59
    v_and_b32 v60, 0xffff0000, v59
    v_add_f32 v60, 0x3727c5ac, v60
    v_cvt_pk_bf16_f32 v59, v60, v61
    v_lshlrev_b32 v60, 16, v59
    v_and_b32 v61, 0xffff0000, v59
    v_sqrt_f32 v60, v60
    s_nop 0
    v_cvt_pk_bf16_f32 v59, v60, v61
    v_lshlrev_b32 v60, 16, v59
    v_and_b32 v61, 0xffff0000, v59
    v_rcp_f32 v60, v60
    v_lshlrev_b32 v62, 16, v171
    v_and_b32 v63, 0xffff0000, v171
    v_sub_f32 v62, v62, v58
    v_sub_f32 v63, v63, v58
    v_cvt_pk_bf16_f32 v59, v62, v63
    v_lshlrev_b32 v62, 16, v59
    v_and_b32 v63, 0xffff0000, v59
    v_mul_f32 v62, v62, v60
    v_mul_f32 v63, v63, v60
    v_cvt_pk_bf16_f32 v59, v62, v63
    v_lshlrev_b32 v62, 16, v59
    v_and_b32 v63, 0xffff0000, v59
    s_mul_i32 s60, s7, 80
    s_mul_i32 s61, s8, 20
    s_add_u32 s60, s60, s61
    v_mul_u32_u24 v2, 30720, v16
    v_lshl_add_u32 v2, v17, 4, v2
    s_lshl_b32 s62, s60, 3
    s_add_u32 s62, s62, 1048576
    s_add_u32 s63, s62, 5120
L_h1b:
    s_mov_b32 s61, 0
sp_20:
    ds_read_b32 v46, v14 offset:24
    s_waitcnt lgkmcnt(0)
    s_cbranch_execz spo_21
    v_readfirstlane_b32 s60, v46
    s_cmp_ge_u32 s60, 4
    s_cbranch_scc1 spo_21
    s_sleep 1
    s_add_u32 s61, s61, 1
    s_cmp_lt_u32 s61, 0x40000
    s_cbranch_scc1 sp_20
spo_21:
    s_mov_b32 s61, 0
    s_mov_b64 s[14:15], exec
pl_22:
    s_cbranch_execz pl_22_s
    buffer_load_dwordx4 v[44:47], v2, s[44:47], s62 offen sc1
    buffer_load_dwordx4 v[48:51], v2, s[44:47], s63 offen sc1
    s_waitcnt vmcnt(0)
pl_22_s:
    v_xor_b32 v53, s9, v45
    v_xor_b32 v54, s9, v47
    v_xor_b32 v55, s9, v49
    v_xor_b32 v56, s9, v51
    v_or3_b32 v53, v53, v54, v55
    v_or_b32 v53, v53, v56
    v_cmp_ne_u32 vcc, 0, v53
    s_cbranch_vccz plo_23
    s_mov_b64 exec, vcc
    s_sleep 8
    s_add_u32 s61, s61, 1
    s_cmp_lt_u32 s61, 0x8000
    s_cbranch_scc1 pl_22
plo_23:
    s_mov_b64 exec, s[14:15]
    v_mov_b32 v53, v44
    s_nop 1
    v_permlane16_swap_b32 v53, v44
    v_add_f32 v44, v44, v53
    v_mov_b32 v53, v44
    s_nop 1
    v_permlane32_swap_b32 v53, v44
    v_add_f32 v44, v44, v53
    v_mov_b32 v53, v46
    s_nop 1
    v_permlane16_swap_b32 v53, v46
    v_add_f32 v46, v46, v53
    v_mov_b32 v53, v46
    s_nop 1
    v_permlane32_swap_b32 v53, v46
    v_add_f32 v46, v46, v53
    v_mov_b32 v53, v48
    s_nop 1
    v_permlane16_swap_b32 v53, v48
    v_add_f32 v48, v48, v53
    v_mov_b32 v53, v48
    s_nop 1
    v_permlane32_swap_b32 v53, v48
    v_add_f32 v48, v48, v53
    v_mov_b32 v53, v50
    s_nop 1
    v_permlane16_swap_b32 v53, v50
    v_add_f32 v50, v50, v53
    v_mov_b32 v53, v50
    s_nop 1
    v_permlane32_swap_b32 v53, v50
    v_add_f32 v50, v50, v53
    v_cvt_pk_bf16_f32 v53, v44, v46
    v_lshlrev_b32 v44, 16, v53
    v_and_b32 v46, 0xffff0000, v53
    v_cvt_pk_bf16_f32 v53, v48, v50
    v_lshlrev_b32 v48, 16, v53
    v_and_b32 v50, 0xffff0000, v53
    v_add_f32 v48, 1.0, v48
    v_add_f32 v50, 1.0, v50
    v_cvt_pk_bf16_f32 v53, v48, v50
    v_lshlrev_b32 v48, 16, v53
    v_and_b32 v50, 0xffff0000, v53
    v_mul_f32 v48, v62, v48
    v_mul_f32 v50, v63, v50
    v_cvt_pk_bf16_f32 v53, v48, v50
    v_lshlrev_b32 v48, 16, v53
    v_and_b32 v50, 0xffff0000, v53
    v_add_f32 v48, v48, v44
    v_add_f32 v50, v50, v46
    v_cvt_pk_bf16_f32 v53, v48, v50
    s_nop 0
    v_readlane_b32 s64, v53, 0
    v_readlane_b32 s65, v53, 1
    v_readlane_b32 s66, v53, 2
    v_readlane_b32 s67, v53, 3
    v_readlane_b32 s68, v53, 4
    v_readlane_b32 s69, v53, 5
    v_readlane_b32 s70, v53, 6
    v_readlane_b32 s71, v53, 7
    v_readlane_b32 s72, v53, 8
    v_readlane_b32 s73, v53, 9
    v_mov_b32 v44, 0
    v_mov_b32 v45, 0
    v_dot2c_f32_bf16 v44, s64, v64
    v_dot2c_f32_bf16 v45, s64, v137
    v_dot2c_f32_bf16 v44, s65, v136
    v_dot2c_f32_bf16 v45, s65, v139
    v_dot2c_f32_bf16 v44, s66, v138
    v_dot2c_f32_bf16 v45, s66, v141
    v_dot2c_f32_bf16 v44, s67, v140
    v_dot2c_f32_bf16 v45, s67, v143
    v_dot2c_f32_bf16 v44, s68, v142
    v_dot2c_f32_bf16 v45, s68, v145
    v_dot2c_f32_bf16 v44, s69, v144
    v_dot2c_f32_bf16 v45, s69, v147
    v_dot2c_f32_bf16 v44, s70, v146
    v_dot2c_f32_bf16 v45, s70, v149
    v_dot2c_f32_bf16 v44, s71, v148
    v_dot2c_f32_bf16 v45, s71, v151
    v_dot2c_f32_bf16 v44, s72, v150
    v_dot2c_f32_bf16 v45, s72, v153
    v_dot2c_f32_bf16 v44, s73, v152
    v_dot2c_f32_bf16 v45, s73, v155
    s_lshl_b32 s60, s8, 9
    s_add_u32 s60, s60, 133120
    v_lshlrev_b32 v2, 3, v0
    v_add_u32 v2, s60, v2
    ds_write_b64 v2, v[44:45]
    s_mov_b64 s[14:15], exec
    s_and_b32 exec_lo, exec_lo, 1
    s_mov_b32 exec_hi, 0
    ds_add_rtn_u32 v46, v14, v15 offset:4
    s_mov_b64 exec, s[14:15]
    s_waitcnt lgkmcnt(0)
    s_cbranch_execz la_26
    v_readfirstlane_b32 s60, v46
    s_cmp_lg_u32 s60, 3
    s_cbranch_scc1 L_h2
la_26:
    v_lshlrev_b32 v2, 4, v0
    v_add_u32 v3, 133120, v2
    s_mov_b64 s[14:15], exec
    s_mov_b32 exec_hi, 0
    ds_read_b128 v[44:47], v3 offset:0
    ds_read_b128 v[48:51], v3 offset:512
    ds_read_b128 v[52:55], v3 offset:1024
    ds_read_b128 v[56:59], v3 offset:1536
    s_lshl_b32 s60, s6, 3
    s_add_u32 s60, s60, s7
    s_lshl_b32 s60, s60, 9
    s_add_u32 s60, s60, 131072
    s_waitcnt lgkmcnt(0)
    v_pk_add_f32 v[44:45], v[44:45], v[48:49]
    v_pk_add_f32 v[52:53], v[52:53], v[56:57]
    v_pk_add_f32 v[46:47], v[46:47], v[50:51]
    v_pk_add_f32 v[54:55], v[54:55], v[58:59]
    v_pk_add_f32 v[44:45], v[44:45], v[52:53]
    v_pk_add_f32 v[46:47], v[46:47], v[54:55]
    v_add_u32 v44, 0x80, v44
    v_bfi_b32 v44, s98, v18, v44
    v_add_u32 v45, 0x80, v45
    v_bfi_b32 v45, s98, v18, v45
    v_add_u32 v46, 0x80, v46
    v_bfi_b32 v46, s98, v18, v46
    v_add_u32 v47, 0x80, v47
    v_bfi_b32 v47, s98, v18, v47
    s_cbranch_execz L_sks677
    buffer_store_dwordx4 v[44:47], v2, s[44:47], s60 offen sc1
L_sks677:
    s_mov_b64 exec, s[14:15]
L_h2:
    s_mov_b64 exec, 0
    s_cmp_eq_u32 s8, 0
    s_cbranch_scc1 L_pv
    s_cmp_eq_u32 s8, 1
    s_cbranch_scc1 L_Gtail
    s_cmp_eq_u32 s8, 2
    s_cbranch_scc1 L_W2
    s_branch L_Gtail2
L_dry_ret:
    s_mov_b64 exec, -1
L_h2b:
    v_lshrrev_b32 v2, 3, v0
    v_lshlrev_b32 v2, 9, v2
    v_and_b32 v3, 7, v0
    v_lshl_add_u32 v2, v3, 4, v2
    s_lshl_b32 s62, s6, 12
    s_lshl_b32 s60, s8, 7
    s_add_u32 s62, s62, s60
    s_add_u32 s62, s62, 131072
    s_cbranch_execz L_M
    s_cmp_lg_u32 s10, 3
    s_cbranch_scc1 L_Mend
    s_cmp_lg_u32 s8, 0
    s_cbranch_scc1 L_Mend
L_M:
    v_and_b32 v4, 15, v0
    v_mul_u32_u24 v5, 30720, v16
    v_lshl_add_u32 v5, v4, 5, v5
    v_lshlrev_b32 v4, 4, v4
    s_lshl_b32 s63, s11, 9
    s_add_u32 s63, s63, 1058816
    s_lshl_b32 s64, s11, 8
    s_add_u32 s64, s64, 65536
    s_mov_b32 s61, 0
    s_mov_b64 s[14:15], exec
pl_27:
    s_cbranch_execz pl_27_s
    buffer_load_dwordx4 v[44:47], v5, s[44:47], s63 offen sc1
    buffer_load_dwordx4 v[48:51], v5, s[44:47], s63 offen offset:16 sc1
    s_waitcnt vmcnt(0)
pl_27_s:
    v_xor_b32 v53, s9, v45
    v_xor_b32 v54, s9, v47
    v_xor_b32 v55, s9, v49
    v_xor_b32 v56, s9, v51
    v_or3_b32 v53, v53, v54, v55
    v_or_b32 v53, v53, v56
    v_cmp_ne_u32 vcc, 0, v53
    s_cbranch_vccz plo_28
    s_mov_b64 exec, vcc
    s_sleep 8
    s_add_u32 s61, s61, 1
    s_cmp_lt_u32 s61, 0x8000
    s_cbranch_scc1 pl_27
plo_28:
    s_mov_b64 exec, s[14:15]
    v_mov_b32 v53, v44
    s_nop 1
    v_permlane16_swap_b32 v53, v44
    v_add_f32 v44, v44, v53
    v_mov_b32 v53, v44
    s_nop 1
    v_permlane32_swap_b32 v53, v44
    v_add_f32 v44, v44, v53
    v_mov_b32 v53, v46
    s_nop 1
    v_permlane16_swap_b32 v53, v46
    v_add_f32 v46, v46, v53
    v_mov_b32 v53, v46
    s_nop 1
    v_permlane32_swap_b32 v53, v46
    v_add_f32 v46, v46, v53
    v_mov_b32 v53, v48
    s_nop 1
    v_permlane16_swap_b32 v53, v48
    v_add_f32 v48, v48, v53
    v_mov_b32 v53, v48
    s_nop 1
    v_permlane32_swap_b32 v53, v48
    v_add_f32 v48, v48, v53
    v_mov_b32 v53, v50
    s_nop 1
    v_permlane16_swap_b32 v53, v50
    v_add_f32 v50, v50, v53
    v_mov_b32 v53, v50
    s_nop 1
    v_permlane32_swap_b32 v53, v50
    v_add_f32 v50, v50, v53
    v_cvt_pk_bf16_f32 v53, v44, v46
    v_lshlrev_b32 v44, 16, v53
    v_and_b32 v46, 0xffff0000, v53
    v_cvt_pk_bf16_f32 v53, v48, v50
    v_lshlrev_b32 v48, 16, v53
    v_and_b32 v50, 0xffff0000, v53
    v_mov_b32 v45, v46
    v_mov_b32 v46, v48
    v_mov_b32 v47, v50
    v_bfi_b32 v44, s98, v18, v44
    v_bfi_b32 v45, s98, v18, v45
    v_bfi_b32 v46, s98, v18, v46
    v_bfi_b32 v47, s98, v18, v47
    s_mov_b64 s[14:15], exec
    s_and_b32 exec_lo, exec_lo, 0xffff
    s_mov_b32 exec_hi, 0
    s_cbranch_execz L_sks784
    buffer_store_dwordx4 v[44:47], v4, s[44:47], s64 offen sc1
L_sks784:
    s_mov_b64 exec, s[14:15]
L_Mend:
    s_mov_b32 s61, 0
sp_31:
    ds_read_b32 v44, v14 offset:28
    s_waitcnt lgkmcnt(0)
    s_cbranch_execz spo_32
    v_readfirstlane_b32 s60, v44
    s_cmp_ge_u32 s60, 4
    s_cbranch_scc1 spo_32
    s_sleep 1
    s_add_u32 s61, s61, 1
    s_cmp_lt_u32 s61, 0x40000
    s_cbranch_scc1 sp_31
spo_32:
    s_mov_b32 s48, s40
    s_mov_b32 s49, s41
    s_mov_b32 s50, 256
    s_mov_b32 s51, 0x20000
    v_mov_b32 v54, 63
    s_and_b32 s63, s5, 3
    s_cbranch_execz L_tk1
    s_cmp_lg_u32 s8, 0
    s_cbranch_scc1 L_tk1
    s_cmp_ge_u32 s5, 24
    s_cbranch_scc1 L_tk1
    s_and_b32 s63, s5, 3
    s_lshl_b32 s60, s63, 6
    v_mov_b32 v54, 1
    v_mov_b32 v55, 0
    s_mov_b64 s[14:15], exec
    s_and_b32 exec_lo, exec_lo, 1
    s_mov_b32 exec_hi, 0
    buffer_atomic_add v54, v55, s[48:51], s60 offen sc0
    s_mov_b64 exec, s[14:15]
L_tk1:
    buffer_load_dwordx4 v[48:51], v2, s[44:47], s62 offen sc1
    v_and_b32 v17, 15, v0
    v_xor_b32 v4, v16, v17
    v_lshlrev_b32 v4, 4, v4
    v_lshl_add_u32 v4, v17, 8, v4
    s_lshl_b32 s60, s8, 15
    v_add_u32 v4, s60, v4
    v_xor_b32 v5, 64, v4
    v_xor_b32 v6, 0x80, v4
    v_xor_b32 v7, 0xc0, v4
    s_mov_b32 s61, 0
sp_33:
    ds_read_b32 v44, v14 offset:12
    s_waitcnt lgkmcnt(0)
    s_cbranch_execz spo_34
    v_readfirstlane_b32 s60, v44
    s_cmp_ge_u32 s60, 4
    s_cbranch_scc1 spo_34
    s_sleep 1
    s_add_u32 s61, s61, 1
    s_cmp_lt_u32 s61, 0x40000
    s_cbranch_scc1 sp_33
spo_34:
    ds_read_b128 v[96:99], v4 offset:0
    ds_read_b128 v[100:103], v5 offset:0
    ds_read_b128 v[104:107], v6 offset:0
    ds_read_b128 v[108:111], v7 offset:0
    ds_read_b128 v[112:115], v4 offset:4096
    ds_read_b128 v[116:119], v5 offset:4096
    ds_read_b128 v[120:123], v6 offset:4096
    ds_read_b128 v[124:127], v7 offset:4096
    ds_read_b128 v[128:131], v4 offset:8192
    ds_read_b128 v[132:135], v5 offset:8192
    ds_read_b128 v[136:139], v6 offset:8192
    ds_read_b128 v[140:143], v7 offset:8192
    ds_read_b128 v[144:147], v4 offset:12288
    ds_read_b128 v[148:151], v5 offset:12288
    ds_read_b128 v[152:155], v6 offset:12288
    ds_read_b128 v[156:159], v7 offset:12288
    ds_read_b128 v[160:163], v4 offset:16384
    ds_read_b128 v[164:167], v5 offset:16384
    ds_read_b128 v[168:171], v6 offset:16384
    ds_read_b128 v[172:175], v7 offset:16384
    ds_read_b128 v[176:179], v4 offset:20480
    ds_read_b128 v[180:183], v5 offset:20480
    ds_read_b128 v[184:187], v6 offset:20480
    ds_read_b128 v[188:191], v7 offset:20480
    ds_read_b128 v[192:195], v4 offset:24576
    ds_read_b128 v[196:199], v5 offset:24576
    ds_read_b128 v[200:203], v6 offset:24576
    ds_read_b128 v[204:207], v7 offset:24576
    ds_read_b128 v[208:211], v4 offset:28672
    ds_read_b128 v[212:215], v5 offset:28672
    ds_read_b128 v[216:219], v6 offset:28672
    ds_read_b128 v[220:223], v7 offset:28672
    s_mov_b32 s61, 0
    s_mov_b64 s[14:15], exec
    s_branch pl_35_c
pl_35:
    s_cbranch_execz pl_35_s
    buffer_load_dwordx4 v[48:51], v2, s[44:47], s62 offen sc1
pl_35_c:
    s_cbranch_execz pl_35_s
    s_waitcnt vmcnt(0)
pl_35_s:
    v_xor_b32 v52, v48, v18
    v_bitop3_b32 v52, v49, v18, v52 bitop3:0xbe
    v_bitop3_b32 v52, v50, v18, v52 bitop3:0xbe
    v_bitop3_b32 v52, v51, v18, v52 bitop3:0xbe
    v_and_b32 v52, s98, v52
    v_cmp_ne_u32 vcc, 0, v52
    s_cbranch_vccz plo_36
    s_mov_b64 exec, vcc
    s_sleep 8
    s_add_u32 s61, s61, 1
    s_cmp_lt_u32 s61, 0x8000
    s_cbranch_scc1 pl_35
plo_36:
    s_mov_b64 exec, s[14:15]
    s_cmp_lg_u32 s8, 0
    s_cbranch_scc1 L_tk2
    s_mov_b64 s[14:15], exec
    s_and_b32 exec_lo, exec_lo, 1
    s_mov_b32 exec_hi, 0
    s_cmp_ge_u32 s5, 24
    s_cbranch_scc1 L_tk3
    v_mul_u32_u24 v55, 43691, v54
    v_lshrrev_b32 v55, 21, v55
    v_mul_u32_u24 v55, 48, v55
    v_sub_u32 v54, v54, v55
L_tk3:
    v_lshlrev_b32 v54, 2, v54
    v_add_u32 v54, s63, v54
    v_add_u32 v54, 1, v54
    ds_write_b32 v14, v54 offset:52
    s_mov_b64 exec, s[14:15]
L_tk2:
    v_permlane32_swap_b32 v48, v50
    v_permlane32_swap_b32 v49, v51
    v_add_f32 v48, v48, v50
    v_add_f32 v49, v49, v51
    s_nop 1
    v_permlane16_swap_b32 v48, v49
    v_add_f32 v48, v48, v49
    s_nop 1
    v_add_f32_dpp v48, v48, v48 row_ror:8 row_mask:0xf bank_mask:0xf
    s_lshl_b32 s60, s8, 6
    s_add_u32 s60, s60, 135168
    v_lshlrev_b32 v3, 3, v3
    v_lshl_add_u32 v3, v16, 1, v3
    v_add_u32 v3, s60, v3
    v_cvt_pk_bf16_f32 v48, v48, v48
    ds_write_b16 v3, v48
    s_mov_b64 s[14:15], exec
    s_and_b32 exec_lo, exec_lo, 1
    s_mov_b32 exec_hi, 0
    ds_add_u32 v14, v15 offset:8
    s_mov_b64 exec, s[14:15]
L_qk2:
    v_lshlrev_b32 v6, 4, v16
    v_add_u32 v6, 135168, v6
    s_mov_b32 s61, 0
sp_39:
    ds_read_b32 v44, v14 offset:8
    s_waitcnt lgkmcnt(0)
    s_cbranch_execz spo_40
    v_readfirstlane_b32 s60, v44
    s_cmp_ge_u32 s60, 4
    s_cbranch_scc1 spo_40
    s_sleep 1
    s_add_u32 s61, s61, 1
    s_cmp_lt_u32 s61, 0x40000
    s_cbranch_scc1 sp_39
spo_40:
    ds_read_b128 v[20:23], v6 offset:0
    ds_read_b128 v[24:27], v6 offset:64
    ds_read_b128 v[28:31], v6 offset:128
    ds_read_b128 v[32:35], v6 offset:192
    s_waitcnt lgkmcnt(0)
    v_mfma_f32_16x16x32_bf16 v[224:227], v[20:23], v[96:99], 0
    v_mfma_f32_16x16x32_bf16 v[228:231], v[20:23], v[112:115], 0
    v_mfma_f32_16x16x32_bf16 v[232:235], v[20:23], v[128:131], 0
    v_mfma_f32_16x16x32_bf16 v[236:239], v[20:23], v[144:147], 0
    v_mfma_f32_16x16x32_bf16 v[240:243], v[20:23], v[160:163], 0
    v_mfma_f32_16x16x32_bf16 v[244:247], v[20:23], v[176:179], 0
    v_mfma_f32_16x16x32_bf16 v[248:251], v[20:23], v[192:195], 0
    v_mfma_f32_16x16x32_bf16 v[252:255], v[20:23], v[208:211], 0
    v_mfma_f32_16x16x32_bf16 v[224:227], v[24:27], v[100:103], v[224:227]
    v_mfma_f32_16x16x32_bf16 v[228:231], v[24:27], v[116:119], v[228:231]
    v_mfma_f32_16x16x32_bf16 v[232:235], v[24:27], v[132:135], v[232:235]
    v_mfma_f32_16x16x32_bf16 v[236:239], v[24:27], v[148:151], v[236:239]
    v_mfma_f32_16x16x32_bf16 v[240:243], v[24:27], v[164:167], v[240:243]
    v_mfma_f32_16x16x32_bf16 v[244:247], v[24:27], v[180:183], v[244:247]
    v_mfma_f32_16x16x32_bf16 v[248:251], v[24:27], v[196:199], v[248:251]
    v_mfma_f32_16x16x32_bf16 v[252:255], v[24:27], v[212:215], v[252:255]
    v_mfma_f32_16x16x32_bf16 v[224:227], v[28:31], v[104:107], v[224:227]
    v_mfma_f32_16x16x32_bf16 v[228:231], v[28:31], v[120:123], v[228:231]
    v_mfma_f32_16x16x32_bf16 v[232:235], v[28:31], v[136:139], v[232:235]
    v_mfma_f32_16x16x32_bf16 v[236:239], v[28:31], v[152:155], v[236:239]
    v_mfma_f32_16x16x32_bf16 v[240:243], v[28:31], v[168:171], v[240:243]
    v_mfma_f32_16x16x32_bf16 v[244:247], v[28:31], v[184:187], v[244:247]
    v_mfma_f32_16x16x32_bf16 v[248:251], v[28:31], v[200:203], v[248:251]
    v_mfma_f32_16x16x32_bf16 v[252:255], v[28:31], v[216:219], v[252:255]
    v_mfma_f32_16x16x32_bf16 v[224:227], v[32:35], v[108:111], v[224:227]
    v_mfma_f32_16x16x32_bf16 v[228:231], v[32:35], v[124:127], v[228:231]
    v_mfma_f32_16x16x32_bf16 v[232:235], v[32:35], v[140:143], v[232:235]
    v_mfma_f32_16x16x32_bf16 v[236:239], v[32:35], v[156:159], v[236:239]
    v_mfma_f32_16x16x32_bf16 v[240:243], v[32:35], v[172:175], v[240:243]
    v_mfma_f32_16x16x32_bf16 v[244:247], v[32:35], v[188:191], v[244:247]
    v_mfma_f32_16x16x32_bf16 v[248:251], v[32:35], v[204:207], v[248:251]
    v_mfma_f32_16x16x32_bf16 v[252:255], v[32:35], v[220:223], v[252:255]
    s_nop 0
    v_mov_b32_dpp v36, v224 quad_perm:[0,1,2,3] row_mask:0x1 bank_mask:0xf
    s_nop 1
    v_mov_b32_dpp v36, v228 quad_perm:[0,1,2,3] row_mask:0x2 bank_mask:0xf
    s_nop 1
    v_mov_b32_dpp v36, v232 quad_perm:[0,1,2,3] row_mask:0x4 bank_mask:0xf
    s_nop 1
    v_mov_b32_dpp v36, v236 quad_perm:[0,1,2,3] row_mask:0x8 bank_mask:0xf
    v_mov_b32_dpp v37, v240 quad_perm:[0,1,2,3] row_mask:0x1 bank_mask:0xf
    s_nop 1
    v_mov_b32_dpp v37, v244 quad_perm:[0,1,2,3] row_mask:0x2 bank_mask:0xf
    s_nop 1
    v_mov_b32_dpp v37, v248 quad_perm:[0,1,2,3] row_mask:0x4 bank_mask:0xf
    s_nop 1
    v_mov_b32_dpp v37, v252 quad_perm:[0,1,2,3] row_mask:0x8 bank_mask:0xf
    v_cvt_pk_bf16_f32 v38, v36, v37
    v_lshlrev_b32 v36, 16, v38
    v_and_b32 v37, 0xffff0000, v38
    v_mul_f32 v36, 0x3db504f3, v36
    v_mul_f32 v37, 0x3db504f3, v37
    v_cvt_pk_bf16_f32 v38, v36, v37
    v_lshlrev_b32 v36, 16, v38
    v_and_b32 v37, 0xffff0000, v38
    v_max_f32 v39, v36, v37
    s_nop 1
    v_max_f32_dpp v39, v39, v39 quad_perm:[1,0,3,2] row_mask:0xf bank_mask:0xf
    s_nop 1
    v_max_f32_dpp v39, v39, v39 quad_perm:[2,3,0,1] row_mask:0xf bank_mask:0xf
    s_nop 1
    v_max_f32_dpp v39, v39, v39 row_half_mirror row_mask:0xf bank_mask:0xf
    s_nop 1
    v_max_f32_dpp v39, v39, v39 row_mirror row_mask:0xf bank_mask:0xf
    v_mov_b32 v38, v39
    s_nop 1
    v_permlane16_swap_b32 v38, v39
    v_max_f32 v39, v39, v38
    v_mov_b32 v38, v39
    s_nop 1
    v_permlane32_swap_b32 v38, v39
    v_max_f32 v39, v39, v38
    s_lshl_b32 s60, s8, 2
    s_add_u32 s60, s60, 135424
    v_mov_b32 v2, s60
    v_mov_b32 v3, 135424
    ds_write_b32 v2, v39
    s_mov_b64 s[14:15], exec
    s_and_b32 exec_lo, exec_lo, 1
    s_mov_b32 exec_hi, 0
    ds_add_u32 v14, v15 offset:20
    s_mov_b64 exec, s[14:15]
    s_mov_b32 s61, 0
sp_41:
    ds_read_b32 v44, v14 offset:20
    s_waitcnt lgkmcnt(0)
    s_cbranch_execz spo_42
    v_readfirstlane_b32 s60, v44
    s_cmp_ge_u32 s60, 4
    s_cbranch_scc1 spo_42
    s_sleep 1
    s_add_u32 s61, s61, 1
    s_cmp_lt_u32 s61, 0x40000
    s_cbranch_scc1 sp_41
spo_42:
    ds_read_b128 v[44:47], v3
    s_lshl_b32 s60, s8, 4
    s_add_u32 s60, s60, 135680
    v_lshlrev_b32 v2, 6, v17
    v_lshl_add_u32 v2, v16, 1, v2
    v_add_u32 v2, s60, v2
    s_waitcnt lgkmcnt(0)
    v_max3_f32 v44, v44, v45, v46
    v_max_f32 v40, v44, v47
    v_sub_f32 v36, v36, v40
    v_sub_f32 v37, v37, v40
    v_mul_f32 v36, 0x3fb8aa3b, v36
    v_mul_f32 v37, 0x3fb8aa3b, v37
    v_exp_f32 v36, v36
    v_exp_f32 v37, v37
    s_nop 0
    v_cvt_pk_bf16_f32 v38, v36, v37
    ds_write_b16 v2, v38
    ds_write_b16_d16_hi v2, v38 offset:8
    v_lshlrev_b32 v36, 16, v38
    v_and_b32 v37, 0xffff0000, v38
    v_add_f32 v41, v36, v37
    s_nop 1
    v_add_f32_dpp v41, v41, v41 quad_perm:[1,0,3,2] row_mask:0xf bank_mask:0xf
    s_nop 1
    v_add_f32_dpp v41, v41, v41 quad_perm:[2,3,0,1] row_mask:0xf bank_mask:0xf
    s_nop 1
    v_add_f32_dpp v41, v41, v41 row_half_mirror row_mask:0xf bank_mask:0xf
    s_nop 1
    v_add_f32_dpp v41, v41, v41 row_mirror row_mask:0xf bank_mask:0xf
    v_mov_b32 v38, v41
    s_nop 1
    v_permlane16_swap_b32 v38, v41
    v_add_f32 v41, v41, v38
    v_mov_b32 v38, v41
    s_nop 1
    v_permlane32_swap_b32 v38, v41
    v_add_f32 v41, v41, v38
    s_lshl_b32 s60, s8, 2
    s_add_u32 s60, s60, 135440
    v_mov_b32 v2, s60
    v_mov_b32 v3, 135440
    ds_write_b32 v2, v41
    ds_write_b32 v3, v40 offset:16
    s_mov_b64 s[14:15], exec
    s_and_b32 exec_lo, exec_lo, 1
    s_mov_b32 exec_hi, 0
    ds_add_u32 v14, v15 offset:16
    s_mov_b64 exec, s[14:15]
    s_sub_u32 s60, s5, 24
    s_lshr_b32 s61, s60, 1
    s_lshl_b32 s61, s61, 3
    s_add_u32 s61, s61, s4
    s_cmp_ge_u32 s60, 8
    s_cbranch_scc1 L_nD
    s_cmp_lt_u32 s61, 27
    s_cbranch_scc1 L_D0
L_nD:
    s_mov_b32 s61, 0
tk_43:
    ds_read_b32 v1, v14 offset:52
    s_waitcnt lgkmcnt(0)
    v_readfirstlane_b32 s94, v1
    s_cbranch_execz tko_44
    s_cmp_lg_u32 s94, 0
    s_cbranch_scc1 tko_44
    s_sleep 1
    s_add_u32 s61, s61, 1
    s_cmp_lt_u32 s61, 0x40000
    s_cbranch_scc1 tk_43
tko_44:
    s_sub_u32 s94, s94, 1
    s_and_b32 s94, s94, 0xff
    s_cmp_ge_u32 s94, 80
    s_cbranch_scc1 L_wend
    s_mov_b32 s61, 0
sp_45:
    ds_read_b32 v44, v14 offset:32
    s_waitcnt lgkmcnt(0)
    s_cbranch_execz spo_46
    v_readfirstlane_b32 s60, v44
    s_cmp_ge_u32 s60, 4
    s_cbranch_scc1 spo_46
    s_sleep 1
    s_add_u32 s61, s61, 1
    s_cmp_lt_u32 s61, 0x40000
    s_cbranch_scc1 sp_45
spo_46:
    s_mov_b32 s48, s24
    s_mov_b32 s49, s25
    s_mov_b32 s50, 5242880
    s_mov_b32 s51, 0x20000
    s_and_b32 s64, s94, 7
    s_lshr_b32 s65, s94, 3
    s_lshl_b32 s66, s64, 2
    s_add_u32 s66, s66, s8
    v_lshrrev_b32 v2, 3, v0
    v_mul_u32_u24 v2, 20480, v2
    v_and_b32 v3, 7, v0
    v_lshl_add_u32 v2, v3, 4, v2
    s_mul_i32 s60, s66, 163840
    s_lshl_b32 s61, s65, 7
    s_add_u32 s60, s60, s61
    buffer_load_dwordx4 v[96:99], v2, s[48:51], s60 offen offset:0 nt
    buffer_load_dwordx4 v[100:103], v2, s[48:51], s60 offen offset:1280 nt
    buffer_load_dwordx4 v[104:107], v2, s[48:51], s60 offen offset:2560 nt
    buffer_load_dwordx4 v[108:111], v2, s[48:51], s60 offen offset:3840 nt
    s_addk_i32 s60, 5120
    buffer_load_dwordx4 v[112:115], v2, s[48:51], s60 offen offset:0 nt
    buffer_load_dwordx4 v[116:119], v2, s[48:51], s60 offen offset:1280 nt
    buffer_load_dwordx4 v[120:123], v2, s[48:51], s60 offen offset:2560 nt
    buffer_load_dwordx4 v[124:127], v2, s[48:51], s60 offen offset:3840 nt
    s_addk_i32 s60, 5120
    s_mov_b32 s62, s60
    s_mov_b32 s61, 0
sp_47:
    ds_read_b32 v44, v14 offset:84
    s_waitcnt lgkmcnt(0)
    s_cbranch_execz spo_48
    v_readfirstlane_b32 s60, v44
    s_cmp_ge_u32 s60, 4
    s_cbranch_scc1 spo_48
    s_sleep 1
    s_add_u32 s61, s61, 1
    s_cmp_lt_u32 s61, 0x40000
    s_cbranch_scc1 sp_47
spo_48:
    s_mov_b32 s60, s62
    buffer_load_dwordx4 v[128:131], v2, s[48:51], s60 offen offset:0 nt
    buffer_load_dwordx4 v[132:135], v2, s[48:51], s60 offen offset:1280 nt
    buffer_load_dwordx4 v[136:139], v2, s[48:51], s60 offen offset:2560 nt
    buffer_load_dwordx4 v[140:143], v2, s[48:51], s60 offen offset:3840 nt
    s_addk_i32 s60, 5120
    buffer_load_dwordx4 v[144:147], v2, s[48:51], s60 offen offset:0 nt
    buffer_load_dwordx4 v[148:151], v2, s[48:51], s60 offen offset:1280 nt
    buffer_load_dwordx4 v[152:155], v2, s[48:51], s60 offen offset:2560 nt
    buffer_load_dwordx4 v[156:159], v2, s[48:51], s60 offen offset:3840 nt
L_W2:
    s_and_b32 s64, s94, 7
    s_lshr_b32 s65, s94, 3
    s_lshl_b32 s66, s64, 2
    s_add_u32 s66, s66, s8
    v_and_b32 v3, 7, v0
    v_lshrrev_b32 v4, 3, v0
    v_lshlrev_b32 v2, 4, v4
    s_lshl_b32 s60, s8, 8
    s_add_u32 s60, s60, 140288
    v_lshlrev_b32 v9, 5, v4
    v_add_u32 v9, s60, v9
    v_lshlrev_b32 v8, 6, v16
    v_lshl_add_u32 v8, v3, 3, v8
    v_add_u32 v8, s60, v8
    v_lshlrev_b32 v4, 9, v4
    v_lshl_add_u32 v4, v3, 4, v4
    s_lshl_b32 s60, s8, 8
    s_add_u32 s60, s60, 139264
    v_lshlrev_b32 v5, 5, v3
    v_lshl_add_u32 v5, v16, 3, v5
    v_add_u32 v5, s60, v5
    v_lshlrev_b32 v6, 4, v0
    v_add_u32 v7, 139264, v6
    s_lshl_b32 s86, s66, 7
    s_add_u32 s86, s86, 393216
    s_lshl_b32 s84, s66, 12
    s_add_u32 s84, s84, 262144
    s_mul_i32 s85, s64, 2560
    s_lshl_b32 s60, s65, 8
    s_add_u32 s85, s85, s60
    s_add_u32 s85, s85, 401408
    s_cbranch_execz wv_49
    s_waitcnt vmcnt(0)
wv_49:
    v_perm_b32 v160, v100, v96, s12
    v_perm_b32 v100, v100, v96, s13
    v_perm_b32 v161, v101, v97, s12
    v_perm_b32 v101, v101, v97, s13
    v_perm_b32 v162, v102, v98, s12
    v_perm_b32 v102, v102, v98, s13
    v_perm_b32 v163, v103, v99, s12
    v_perm_b32 v103, v103, v99, s13
    v_perm_b32 v96, v108, v104, s12
    v_perm_b32 v108, v108, v104, s13
    v_perm_b32 v97, v109, v105, s12
    v_perm_b32 v109, v109, v105, s13
    v_perm_b32 v98, v110, v106, s12
    v_perm_b32 v110, v110, v106, s13
    v_perm_b32 v99, v111, v107, s12
    v_perm_b32 v111, v111, v107, s13
    v_perm_b32 v104, v116, v112, s12
    v_perm_b32 v116, v116, v112, s13
    v_perm_b32 v105, v117, v113, s12
    v_perm_b32 v117, v117, v113, s13
    v_perm_b32 v106, v118, v114, s12
    v_perm_b32 v118, v118, v114, s13
    v_perm_b32 v107, v119, v115, s12
    v_perm_b32 v119, v119, v115, s13
    v_perm_b32 v112, v124, v120, s12
    v_perm_b32 v124, v124, v120, s13
    v_perm_b32 v113, v125, v121, s12
    v_perm_b32 v125, v125, v121, s13
    v_perm_b32 v114, v126, v122, s12
    v_perm_b32 v126, v126, v122, s13
    v_perm_b32 v115, v127, v123, s12
    v_perm_b32 v127, v127, v123, s13
    v_perm_b32 v120, v132, v128, s12
    v_perm_b32 v132, v132, v128, s13
    v_perm_b32 v121, v133, v129, s12
    v_perm_b32 v133, v133, v129, s13
    v_perm_b32 v122, v134, v130, s12
    v_perm_b32 v134, v134, v130, s13
    v_perm_b32 v123, v135, v131, s12
    v_perm_b32 v135, v135, v131, s13
    v_perm_b32 v128, v140, v136, s12
    v_perm_b32 v140, v140, v136, s13
    v_perm_b32 v129, v141, v137, s12
    v_perm_b32 v141, v141, v137, s13
    v_perm_b32 v130, v142, v138, s12
    v_perm_b32 v142, v142, v138, s13
    v_perm_b32 v131, v143, v139, s12
    v_perm_b32 v143, v143, v139, s13
    v_perm_b32 v136, v148, v144, s12
    v_perm_b32 v148, v148, v144, s13
    v_perm_b32 v137, v149, v145, s12
    v_perm_b32 v149, v149, v145, s13
    v_perm_b32 v138, v150, v146, s12
    v_perm_b32 v150, v150, v146, s13
    v_perm_b32 v139, v151, v147, s12
    v_perm_b32 v151, v151, v147, s13
    v_perm_b32 v144, v156, v152, s12
    v_perm_b32 v156, v156, v152, s13
    v_perm_b32 v145, v157, v153, s12
    v_perm_b32 v157, v157, v153, s13
    v_perm_b32 v146, v158, v154, s12
    v_perm_b32 v158, v158, v154, s13
    v_perm_b32 v147, v159, v155, s12
    v_perm_b32 v159, v159, v155, s13
    s_mov_b32 s61, 0
sp_50:
    ds_read_b32 v44, v14 offset:72
    s_waitcnt lgkmcnt(0)
    s_cbranch_execz spo_51
    v_readfirstlane_b32 s60, v44
    s_cmp_ge_u32 s60, 4
    s_cbranch_scc1 spo_51
    s_sleep 1
    s_add_u32 s61, s61, 1
    s_cmp_lt_u32 s61, 0x40000
    s_cbranch_scc1 sp_50
spo_51:
    s_mov_b32 s61, 0
    s_mov_b64 s[14:15], exec
pl_52:
    s_cbranch_execz pl_52_s
    buffer_load_dwordx4 v[60:63], v2, s[44:47], s86 offen sc1
    buffer_load_dwordx4 v[44:47], v4, s[44:47], s84 offen offset:0 sc1
    buffer_load_dwordx4 v[48:51], v4, s[44:47], s84 offen offset:128 sc1
    buffer_load_dwordx4 v[52:55], v4, s[44:47], s84 offen offset:256 sc1
    buffer_load_dwordx4 v[56:59], v4, s[44:47], s84 offen offset:384 sc1
    s_waitcnt vmcnt(0)
pl_52_s:
    v_xor_b32 v64, v44, v18
    v_bitop3_b32 v64, v45, v18, v64 bitop3:0xbe
    v_bitop3_b32 v64, v46, v18, v64 bitop3:0xbe
    v_bitop3_b32 v64, v47, v18, v64 bitop3:0xbe
    v_bitop3_b32 v64, v48, v18, v64 bitop3:0xbe
    v_bitop3_b32 v64, v49, v18, v64 bitop3:0xbe
    v_bitop3_b32 v64, v50, v18, v64 bitop3:0xbe
    v_bitop3_b32 v64, v51, v18, v64 bitop3:0xbe
    v_bitop3_b32 v64, v52, v18, v64 bitop3:0xbe
    v_bitop3_b32 v64, v53, v18, v64 bitop3:0xbe
    v_bitop3_b32 v64, v54, v18, v64 bitop3:0xbe
    v_bitop3_b32 v64, v55, v18, v64 bitop3:0xbe
    v_bitop3_b32 v64, v56, v18, v64 bitop3:0xbe
    v_bitop3_b32 v64, v57, v18, v64 bitop3:0xbe
    v_bitop3_b32 v64, v58, v18, v64 bitop3:0xbe
    v_bitop3_b32 v64, v59, v18, v64 bitop3:0xbe
    v_bitop3_b32 v64, v60, v18, v64 bitop3:0xbe
    v_bitop3_b32 v64, v61, v18, v64 bitop3:0xbe
    v_bitop3_b32 v64, v62, v18, v64 bitop3:0xbe
    v_bitop3_b32 v64, v63, v18, v64 bitop3:0xbe
    v_and_b32 v64, s98, v64
    v_cmp_ne_u32 vcc, 0, v64
    s_cbranch_vccz plo_53
    s_mov_b64 exec, vcc
    s_add_u32 s61, s61, 1
    s_cmp_lt_u32 s61, 0x8000
    s_cbranch_scc1 pl_52
plo_53:
    s_mov_b64 exec, s[14:15]
    v_and_b32 v60, 0xffff0000, v60
    s_nop 1
    v_max_f32_dpp v62, v60, v60 row_ror:8 row_mask:0xf bank_mask:0xf
    v_mov_b32 v64, v62
    s_nop 1
    v_permlane16_swap_b32 v64, v62
    v_max_f32 v62, v62, v64
    v_mov_b32 v64, v62
    s_nop 1
    v_permlane32_swap_b32 v64, v62
    v_max_f32 v62, v62, v64
    v_sub_f32 v60, v60, v62
    v_mul_f32 v60, 0x3fb8aa3b, v60
    v_exp_f32 v66, v60
    s_nop 0
    v_mul_f32 v61, v61, v66
    v_pk_mul_f32 v[44:45], v[44:45], v[66:67] op_sel_hi:[1,0]
    v_pk_mul_f32 v[46:47], v[46:47], v[66:67] op_sel_hi:[1,0]
    v_pk_mul_f32 v[48:49], v[48:49], v[66:67] op_sel_hi:[1,0]
    v_pk_mul_f32 v[50:51], v[50:51], v[66:67] op_sel_hi:[1,0]
    v_pk_mul_f32 v[52:53], v[52:53], v[66:67] op_sel_hi:[1,0]
    v_pk_mul_f32 v[54:55], v[54:55], v[66:67] op_sel_hi:[1,0]
    v_pk_mul_f32 v[56:57], v[56:57], v[66:67] op_sel_hi:[1,0]
    v_pk_mul_f32 v[58:59], v[58:59], v[66:67] op_sel_hi:[1,0]
    v_permlane32_swap_b32 v44, v52
    v_permlane32_swap_b32 v45, v53
    v_permlane32_swap_b32 v46, v54
    v_permlane32_swap_b32 v47, v55
    v_permlane32_swap_b32 v48, v56
    v_permlane32_swap_b32 v49, v57
    v_permlane32_swap_b32 v50, v58
    v_permlane32_swap_b32 v51, v59
    v_pk_add_f32 v[44:45], v[44:45], v[52:53]
    v_pk_add_f32 v[46:47], v[46:47], v[54:55]
    v_pk_add_f32 v[48:49], v[48:49], v[56:57]
    v_pk_add_f32 v[50:51], v[50:51], v[58:59]
    v_add_f32_dpp v61, v61, v61 row_ror:8 row_mask:0xf bank_mask:0xf
    v_permlane16_swap_b32 v44, v48
    v_permlane16_swap_b32 v45, v49
    v_permlane16_swap_b32 v46, v50
    v_permlane16_swap_b32 v47, v51
    v_pk_add_f32 v[44:45], v[44:45], v[48:49]
    v_pk_add_f32 v[46:47], v[46:47], v[50:51]
    s_nop 0
    v_add_f32_dpp v44, v44, v44 row_ror:8 row_mask:0xf bank_mask:0xf
    v_add_f32_dpp v45, v45, v45 row_ror:8 row_mask:0xf bank_mask:0xf
    v_add_f32_dpp v46, v46, v46 row_ror:8 row_mask:0xf bank_mask:0xf
    v_add_f32_dpp v47, v47, v47 row_ror:8 row_mask:0xf bank_mask:0xf
    v_cvt_pk_bf16_f32 v48, v44, v45
    v_cvt_pk_bf16_f32 v49, v46, v47
    ds_write_b64 v8, v[48:49]
    ds_read_b128 v[52:55], v9
    ds_read_b128 v[56:59], v9 offset:16
    v_mov_b32 v64, v61
    s_nop 1
    v_permlane16_swap_b32 v64, v61
    v_add_f32 v61, v61, v64
    v_mov_b32 v64, v61
    s_nop 1
    v_permlane32_swap_b32 v64, v61
    v_add_f32 v61, v61, v64
    v_rcp_f32 v66, v61
    s_waitcnt lgkmcnt(0)
    v_dot2_f32_bf16 v24, v160, v52, 0
    v_dot2_f32_bf16 v25, v100, v52, 0
    v_dot2_f32_bf16 v26, v161, v52, 0
    v_dot2_f32_bf16 v27, v101, v52, 0
    v_dot2_f32_bf16 v28, v162, v52, 0
    v_dot2_f32_bf16 v29, v102, v52, 0
    v_dot2_f32_bf16 v30, v163, v52, 0
    v_dot2_f32_bf16 v31, v103, v52, 0
    v_dot2c_f32_bf16 v24, v96, v53
    v_dot2c_f32_bf16 v25, v108, v53
    v_dot2c_f32_bf16 v26, v97, v53
    v_dot2c_f32_bf16 v27, v109, v53
    v_dot2c_f32_bf16 v28, v98, v53
    v_dot2c_f32_bf16 v29, v110, v53
    v_dot2c_f32_bf16 v30, v99, v53
    v_dot2c_f32_bf16 v31, v111, v53
    v_dot2c_f32_bf16 v24, v104, v54
    v_dot2c_f32_bf16 v25, v116, v54
    v_dot2c_f32_bf16 v26, v105, v54
    v_dot2c_f32_bf16 v27, v117, v54
    v_dot2c_f32_bf16 v28, v106, v54
    v_dot2c_f32_bf16 v29, v118, v54
    v_dot2c_f32_bf16 v30, v107, v54
    v_dot2c_f32_bf16 v31, v119, v54
    v_dot2c_f32_bf16 v24, v112, v55
    v_dot2c_f32_bf16 v25, v124, v55
    v_dot2c_f32_bf16 v26, v113, v55
    v_dot2c_f32_bf16 v27, v125, v55
    v_dot2c_f32_bf16 v28, v114, v55
    v_dot2c_f32_bf16 v29, v126, v55
    v_dot2c_f32_bf16 v30, v115, v55
    v_dot2c_f32_bf16 v31, v127, v55
    v_dot2c_f32_bf16 v24, v120, v56
    v_dot2c_f32_bf16 v25, v132, v56
    v_dot2c_f32_bf16 v26, v121, v56
    v_dot2c_f32_bf16 v27, v133, v56
    v_dot2c_f32_bf16 v28, v122, v56
    v_dot2c_f32_bf16 v29, v134, v56
    v_dot2c_f32_bf16 v30, v123, v56
    v_dot2c_f32_bf16 v31, v135, v56
    v_dot2c_f32_bf16 v24, v128, v57
    v_dot2c_f32_bf16 v25, v140, v57
    v_dot2c_f32_bf16 v26, v129, v57
    v_dot2c_f32_bf16 v27, v141, v57
    v_dot2c_f32_bf16 v28, v130, v57
    v_dot2c_f32_bf16 v29, v142, v57
    v_dot2c_f32_bf16 v30, v131, v57
    v_dot2c_f32_bf16 v31, v143, v57
    v_dot2c_f32_bf16 v24, v136, v58
    v_dot2c_f32_bf16 v25, v148, v58
    v_dot2c_f32_bf16 v26, v137, v58
    v_dot2c_f32_bf16 v27, v149, v58
    v_dot2c_f32_bf16 v28, v138, v58
    v_dot2c_f32_bf16 v29, v150, v58
    v_dot2c_f32_bf16 v30, v139, v58
    v_dot2c_f32_bf16 v31, v151, v58
    v_dot2c_f32_bf16 v24, v144, v59
    v_dot2c_f32_bf16 v25, v156, v59
    v_dot2c_f32_bf16 v26, v145, v59
    v_dot2c_f32_bf16 v27, v157, v59
    v_dot2c_f32_bf16 v28, v146, v59
    v_dot2c_f32_bf16 v29, v158, v59
    v_dot2c_f32_bf16 v30, v147, v59
    v_dot2c_f32_bf16 v31, v159, v59
    v_permlane32_swap_b32 v24, v28
    v_permlane32_swap_b32 v25, v29
    v_permlane32_swap_b32 v26, v30
    v_permlane32_swap_b32 v27, v31
    v_add_f32 v24, v24, v28
    v_add_f32 v25, v25, v29
    v_add_f32 v26, v26, v30
    v_add_f32 v27, v27, v31
    s_nop 0
    v_permlane16_swap_b32 v24, v26
    v_permlane16_swap_b32 v25, v27
    v_add_f32 v24, v24, v26
    v_add_f32 v25, v25, v27
    s_nop 0
    v_add_f32_dpp v24, v24, v24 row_ror:8 row_mask:0xf bank_mask:0xf
    v_add_f32_dpp v25, v25, v25 row_ror:8 row_mask:0xf bank_mask:0xf
    v_pk_mul_f32 v[24:25], v[24:25], v[66:67] op_sel_hi:[1,0]
    ds_write_b64 v5, v[24:25]
    s_mov_b64 s[14:15], exec
    s_and_b32 exec_lo, exec_lo, 1
    s_mov_b32 exec_hi, 0
    ds_add_rtn_u32 v64, v14, v15 offset:40
    s_mov_b64 exec, s[14:15]
    s_waitcnt lgkmcnt(0)
    s_cbranch_execz la_56
    v_readfirstlane_b32 s60, v64
    s_cmp_lg_u32 s60, 3
    s_cbranch_scc1 L_wend
la_56:
    s_and_b32 exec_lo, exec_lo, 0xffff
    s_mov_b32 exec_hi, 0
    ds_read_b128 v[76:79], v7 offset:0
    ds_read_b128 v[80:83], v7 offset:256
    ds_read_b128 v[84:87], v7 offset:512
    ds_read_b128 v[88:91], v7 offset:768
    s_waitcnt lgkmcnt(0)
    v_pk_add_f32 v[76:77], v[76:77], v[80:81]
    v_pk_add_f32 v[84:85], v[84:85], v[88:89]
    v_pk_add_f32 v[78:79], v[78:79], v[82:83]
    v_pk_add_f32 v[86:87], v[86:87], v[90:91]
    v_pk_add_f32 v[76:77], v[76:77], v[84:85]
    v_pk_add_f32 v[78:79], v[78:79], v[86:87]
    v_bfi_b32 v76, s98, v18, v76
    v_bfi_b32 v77, s98, v18, v77
    v_bfi_b32 v78, s98, v18, v78
    v_bfi_b32 v79, s98, v18, v79
    s_cbranch_execz L_sks1517
    buffer_store_dwordx4 v[76:79], v6, s[44:47], s85 offen sc1
L_sks1517:
    s_branch L_wend
L_D0:
    s_lshl_b32 s11, s61, 1
    s_and_b32 s60, s60, 1
    s_add_u32 s11, s11, s60
    s_mov_b32 s48, s16
    s_mov_b32 s49, s17
    s_mov_b32 s50, 1280
    s_mov_b32 s51, 0x20000
    s_mov_b32 s56, s32
    s_mov_b32 s57, s33
    s_mov_b32 s58, 2211840
    s_mov_b32 s59, 0x20000
    v_lshlrev_b32 v2, 4, v0
    s_mul_i32 s65, s8, 2560
    s_add_u32 s62, s65, 65536
    v_min_u32 v3, 31, v0
    v_lshlrev_b32 v3, 4, v3
    v_min_u32 v4, 39, v0
    v_lshlrev_b32 v5, 3, v4
    s_mul_i32 s60, s8, 320
    buffer_load_dwordx2 v[56:57], v5, s[48:51], s60 offen
    s_mov_b32 s61, 0
    s_mov_b64 s[14:15], exec
pl_57:
    s_cbranch_execz pl_57_s
    buffer_load_dwordx4 v[44:47], v2, s[44:47], s62 offen sc1
    buffer_load_dwordx4 v[48:51], v2, s[44:47], s62 offen offset:1024 sc1
    buffer_load_dwordx4 v[52:55], v3, s[44:47], s62 offen offset:2048 sc1
    s_waitcnt vmcnt(0)
pl_57_s:
    v_xor_b32 v60, v44, v18
    v_bitop3_b32 v60, v45, v18, v60 bitop3:0xbe
    v_bitop3_b32 v60, v46, v18, v60 bitop3:0xbe
    v_bitop3_b32 v60, v47, v18, v60 bitop3:0xbe
    v_bitop3_b32 v60, v48, v18, v60 bitop3:0xbe
    v_bitop3_b32 v60, v49, v18, v60 bitop3:0xbe
    v_bitop3_b32 v60, v50, v18, v60 bitop3:0xbe
    v_bitop3_b32 v60, v51, v18, v60 bitop3:0xbe
    v_bitop3_b32 v60, v52, v18, v60 bitop3:0xbe
    v_bitop3_b32 v60, v53, v18, v60 bitop3:0xbe
    v_bitop3_b32 v60, v54, v18, v60 bitop3:0xbe
    v_bitop3_b32 v60, v55, v18, v60 bitop3:0xbe
    v_and_b32 v60, s98, v60
    v_cmp_ne_u32 vcc, 0, v60
    s_cbranch_vccz plo_58
    s_mov_b64 exec, vcc
    s_sleep 4
    s_add_u32 s61, s61, 1
    s_cmp_lt_u32 s61, 0x8000
    s_cbranch_scc1 pl_57
plo_58:
    s_mov_b64 exec, s[14:15]
    v_and_b32 v44, 0xffff0000, v44
    v_and_b32 v45, 0xffff0000, v45
    v_and_b32 v46, 0xffff0000, v46
    v_and_b32 v47, 0xffff0000, v47
    v_and_b32 v48, 0xffff0000, v48
    v_and_b32 v49, 0xffff0000, v49
    v_and_b32 v50, 0xffff0000, v50
    v_and_b32 v51, 0xffff0000, v51
    v_and_b32 v52, 0xffff0000, v52
    v_and_b32 v53, 0xffff0000, v53
    v_and_b32 v54, 0xffff0000, v54
    v_and_b32 v55, 0xffff0000, v55
    v_lshlrev_b32 v60, 16, v56
    v_and_b32 v61, 0xffff0000, v56
    v_lshlrev_b32 v62, 16, v57
    v_and_b32 v63, 0xffff0000, v57
    s_mov_b32 s61, 0
sp_61:
    ds_read_b32 v64, v14 offset:16
    s_waitcnt lgkmcnt(0)
    s_cbranch_execz spo_62
    v_readfirstlane_b32 s60, v64
    s_cmp_ge_u32 s60, 4
    s_cbranch_scc1 spo_62
    s_sleep 1
    s_add_u32 s61, s61, 1
    s_cmp_lt_u32 s61, 0x40000
    s_cbranch_scc1 sp_61
spo_62:
    v_add_u32 v2, s65, v2
    v_add_u32 v3, s65, v3
    s_mul_i32 s60, s8, 640
    v_lshlrev_b32 v4, 4, v4
    v_add_u32 v4, s60, v4
    ds_write_b128 v2, v[44:47] offset:0
    ds_write_b128 v2, v[48:51] offset:1024
    ds_write_b128 v3, v[52:55] offset:2048
    ds_write_b128 v4, v[60:63] offset:10240
    s_mov_b64 s[14:15], exec
    s_and_b32 exec_lo, exec_lo, 1
    s_mov_b32 exec_hi, 0
    ds_add_u32 v14, v15 offset:76
    s_mov_b64 exec, s[14:15]
    s_mul_i32 s64, s8, 192
    s_cmp_eq_u32 s8, 3
    s_cselect_b32 s64, 512, s64
    s_cmp_ge_u32 s8, 2
    s_cselect_b32 s67, 31, 47
    s_cselect_b32 s71, 0, 0xffff
    v_min_u32 v8, s67, v0
    v_lshlrev_b32 v9, 3, v8
    v_lshlrev_b32 v8, 4, v8
    s_lshl_b32 s60, s64, 1
    s_mul_i32 s63, s11, 40960
    s_add_u32 s63, s63, s60
    s_mul_i32 s70, s11, 2560
    s_lshl_b32 s60, s64, 2
    s_add_u32 s70, s70, s60
    s_add_u32 s70, s70, 442368
    v_and_b32 v10, 3, v0
    v_lshlrev_b32 v10, 4, v10
    s_min_u32 s69, s11, 39
    s_lshl_b32 s69, s69, 6
    v_lshlrev_b32 v7, 2, v0
    v_add_u32 v7, 142848, v7
    v_lshl_add_u32 v12, v16, 2, v10
    v_add_u32 v12, s69, v12
    v_add_u32 v11, 143872, v12
    v_mov_b32 v55, 0x3d372713
    s_mov_b32 s61, 0
sp_63:
    ds_read_b32 v64, v14 offset:80
    s_waitcnt lgkmcnt(0)
    s_cbranch_execz spo_64
    v_readfirstlane_b32 s60, v64
    s_cmp_ge_u32 s60, 4
    s_cbranch_scc1 spo_64
    s_sleep 1
    s_add_u32 s61, s61, 1
    s_cmp_lt_u32 s61, 0x40000
    s_cbranch_scc1 sp_63
spo_64:
    s_setprio 3
    buffer_load_dwordx2 v[96:97], v9, s[56:59], s63 offen offset:0
    buffer_load_dwordx2 v[98:99], v9, s[56:59], s63 offen offset:1280
    buffer_load_dwordx2 v[100:101], v9, s[56:59], s63 offen offset:2560
    buffer_load_dwordx2 v[102:103], v9, s[56:59], s63 offen offset:3840
    s_addk_i32 s63, 5120
    buffer_load_dwordx2 v[104:105], v9, s[56:59], s63 offen offset:0
    buffer_load_dwordx2 v[106:107], v9, s[56:59], s63 offen offset:1280
    buffer_load_dwordx2 v[108:109], v9, s[56:59], s63 offen offset:2560
    buffer_load_dwordx2 v[110:111], v9, s[56:59], s63 offen offset:3840
    s_addk_i32 s63, 5120
    buffer_load_dwordx2 v[112:113], v9, s[56:59], s63 offen offset:0
    buffer_load_dwordx2 v[114:115], v9, s[56:59], s63 offen offset:1280
    buffer_load_dwordx2 v[116:117], v9, s[56:59], s63 offen offset:2560
    buffer_load_dwordx2 v[118:119], v9, s[56:59], s63 offen offset:3840
    s_addk_i32 s63, 5120
    buffer_load_dwordx2 v[120:121], v9, s[56:59], s63 offen offset:0
    buffer_load_dwordx2 v[122:123], v9, s[56:59], s63 offen offset:1280
    buffer_load_dwordx2 v[124:125], v9, s[56:59], s63 offen offset:2560
    buffer_load_dwordx2 v[126:127], v9, s[56:59], s63 offen offset:3840
    s_addk_i32 s63, 5120
    buffer_load_dwordx2 v[128:129], v9, s[56:59], s63 offen offset:0
    buffer_load_dwordx2 v[130:131], v9, s[56:59], s63 offen offset:1280
    buffer_load_dwordx2 v[132:133], v9, s[56:59], s63 offen offset:2560
    buffer_load_dwordx2 v[134:135], v9, s[56:59], s63 offen offset:3840
    s_addk_i32 s63, 5120
    buffer_load_dwordx2 v[136:137], v9, s[56:59], s63 offen offset:0
    buffer_load_dwordx2 v[138:139], v9, s[56:59], s63 offen offset:1280
    buffer_load_dwordx2 v[140:141], v9, s[56:59], s63 offen offset:2560
    buffer_load_dwordx2 v[142:143], v9, s[56:59], s63 offen offset:3840
    s_addk_i32 s63, 5120
    buffer_load_dwordx2 v[144:145], v9, s[56:59], s63 offen offset:0
    buffer_load_dwordx2 v[146:147], v9, s[56:59], s63 offen offset:1280
    buffer_load_dwordx2 v[148:149], v9, s[56:59], s63 offen offset:2560
    buffer_load_dwordx2 v[150:151], v9, s[56:59], s63 offen offset:3840
    s_addk_i32 s63, 5120
    buffer_load_dwordx2 v[152:153], v9, s[56:59], s63 offen offset:0
    buffer_load_dwordx2 v[154:155], v9, s[56:59], s63 offen offset:1280
    buffer_load_dwordx2 v[156:157], v9, s[56:59], s63 offen offset:2560
    buffer_load_dwordx2 v[158:159], v9, s[56:59], s63 offen offset:3840
L_Dp:
    s_mov_b32 s61, 0
sp_65:
    ds_read_b32 v64, v14 offset:76
    s_waitcnt lgkmcnt(0)
    s_cbranch_execz spo_66
    v_readfirstlane_b32 s60, v64
    s_cmp_ge_u32 s60, 4
    s_cbranch_scc1 spo_66
    s_sleep 1
    s_add_u32 s61, s61, 1
    s_cmp_lt_u32 s61, 0x40000
    s_cbranch_scc1 sp_65
spo_66:
    ds_read_b32 v57, v12 offset:7680
    s_waitcnt lgkmcnt(0)
    s_cbranch_execz wv_67
    s_waitcnt vmcnt(0)
wv_67:
    v_perm_b32 v160, v98, v96, s12
    v_perm_b32 v98, v98, v96, s13
    v_perm_b32 v161, v99, v97, s12
    v_perm_b32 v99, v99, v97, s13
    v_perm_b32 v96, v102, v100, s12
    v_perm_b32 v102, v102, v100, s13
    v_perm_b32 v97, v103, v101, s12
    v_perm_b32 v103, v103, v101, s13
    v_perm_b32 v100, v106, v104, s12
    v_perm_b32 v106, v106, v104, s13
    v_perm_b32 v101, v107, v105, s12
    v_perm_b32 v107, v107, v105, s13
    v_perm_b32 v104, v110, v108, s12
    v_perm_b32 v110, v110, v108, s13
    v_perm_b32 v105, v111, v109, s12
    v_perm_b32 v111, v111, v109, s13
    v_perm_b32 v108, v114, v112, s12
    v_perm_b32 v114, v114, v112, s13
    v_perm_b32 v109, v115, v113, s12
    v_perm_b32 v115, v115, v113, s13
    v_perm_b32 v112, v118, v116, s12
    v_perm_b32 v118, v118, v116, s13
    v_perm_b32 v113, v119, v117, s12
    v_perm_b32 v119, v119, v117, s13
    v_perm_b32 v116, v122, v120, s12
    v_perm_b32 v122, v122, v120, s13
    v_perm_b32 v117, v123, v121, s12
    v_perm_b32 v123, v123, v121, s13
    v_perm_b32 v120, v126, v124, s12
    v_perm_b32 v126, v126, v124, s13
    v_perm_b32 v121, v127, v125, s12
    v_perm_b32 v127, v127, v125, s13
    v_perm_b32 v124, v130, v128, s12
    v_perm_b32 v130, v130, v128, s13
    v_perm_b32 v125, v131, v129, s12
    v_perm_b32 v131, v131, v129, s13
    v_perm_b32 v128, v134, v132, s12
    v_perm_b32 v134, v134, v132, s13
    v_perm_b32 v129, v135, v133, s12
    v_perm_b32 v135, v135, v133, s13
    v_perm_b32 v132, v138, v136, s12
    v_perm_b32 v138, v138, v136, s13
    v_perm_b32 v133, v139, v137, s12
    v_perm_b32 v139, v139, v137, s13
    v_perm_b32 v136, v142, v140, s12
    v_perm_b32 v142, v142, v140, s13
    v_perm_b32 v137, v143, v141, s12
    v_perm_b32 v143, v143, v141, s13
    v_perm_b32 v140, v146, v144, s12
    v_perm_b32 v146, v146, v144, s13
    v_perm_b32 v141, v147, v145, s12
    v_perm_b32 v147, v147, v145, s13
    v_perm_b32 v144, v150, v148, s12
    v_perm_b32 v150, v150, v148, s13
    v_perm_b32 v145, v151, v149, s12
    v_perm_b32 v151, v151, v149, s13
    v_perm_b32 v148, v154, v152, s12
    v_perm_b32 v154, v154, v152, s13
    v_perm_b32 v149, v155, v153, s12
    v_perm_b32 v155, v155, v153, s13
    v_perm_b32 v152, v158, v156, s12
    v_perm_b32 v158, v158, v156, s13
    v_perm_b32 v153, v159, v157, s12
    v_perm_b32 v159, v159, v157, s13
    s_setprio 3
    s_mov_b32 s61, 0
sp_68:
    ds_read_b32 v64, v14 offset:44
    s_waitcnt lgkmcnt(0)
    s_cbranch_execz spo_69
    v_readfirstlane_b32 s60, v64
    s_cmp_ge_u32 s60, 4
    s_cbranch_scc1 spo_69
    s_sleep 1
    s_add_u32 s61, s61, 1
    s_cmp_lt_u32 s61, 0x40000
    s_cbranch_scc1 sp_68
spo_69:
    v_lshlrev_b32 v1, 2, v0
    v_mov_b32 v13, 142592
    ds_read_b32 v64, v1 offset:16384
    ds_read_b32 v68, v1 offset:17408
    ds_read_b32 v65, v1 offset:16640
    ds_read_b32 v69, v1 offset:17664
    ds_read_b32 v66, v1 offset:16896
    ds_read_b32 v70, v1 offset:17920
    ds_read_b32 v67, v1 offset:17152
    ds_read_b32 v71, v1 offset:18176
    s_waitcnt lgkmcnt(0)
    v_add_f32 v64, v64, v65
    v_add_f32 v66, v66, v67
    v_add_f32 v58, v64, v66
    v_add_f32 v68, v68, v69
    v_add_f32 v70, v70, v71
    v_add_f32 v59, v68, v70
    s_cbranch_execz bar_70
    s_barrier
bar_70:
L_Gtail2:
    ds_read_b32 v64, v7 offset:0
    ds_read_b32 v65, v7 offset:256
    ds_read_b32 v66, v7 offset:512
    ds_read_b32 v67, v7 offset:768
    ds_read_b128 v[68:71], v13
    ds_read_b128 v[72:75], v13 offset:16
    ds_read_b32 v56, v11
    s_waitcnt lgkmcnt(1)
    v_pk_add_f32 v[68:69], v[68:69], v[70:71]
    v_pk_add_f32 v[72:73], v[72:73], v[74:75]
    v_add_f32 v64, v64, v65
    v_add_f32 v66, v66, v67
    v_pk_add_f32 v[68:69], v[68:69], v[72:73]
    v_add_f32 v64, v64, v66
    v_mul_f32 v68, 0x3acccccd, v68
    v_mul_f32 v69, 0x3acccccd, v69
    v_fma_f32 v69, -v68, v68, v69
    v_add_f32 v69, 0x3727c5ac, v69
    v_rsq_f32 v69, v69
    v_fma_f32 v64, -v68, v58, v64
    v_fma_f32 v64, v69, v64, v59
    v_mov_b32 v65, v64
    s_nop 1
    v_permlane32_swap_b32 v64, v65
    v_mul_f32 v66, v64, v64
    v_fma_f32 v66, v66, v55, 1.0
    v_mul_f32 v66, v66, v64
    v_mul_f32 v66, 0xc0135761, v66
    v_exp_f32 v66, v66
    v_mul_f32 v64, v64, v65
    v_add_f32 v66, 1.0, v66
    v_rcp_f32 v66, v66
    s_nop 0
    v_mul_f32 v64, v64, v66
    s_nop 1
    v_mov_b32_dpp v65, v64 quad_perm:[1,1,3,3] row_mask:0xf bank_mask:0xf
    v_cvt_pk_bf16_f32 v64, v64, v65
    s_nop 0
    v_readlane_b32 s76, v64, 0
    v_readlane_b32 s77, v64, 2
    v_readlane_b32 s78, v64, 4
    v_readlane_b32 s79, v64, 6
    v_readlane_b32 s80, v64, 8
    v_readlane_b32 s81, v64, 10
    v_readlane_b32 s82, v64, 12
    v_readlane_b32 s83, v64, 14
    v_readlane_b32 s84, v64, 16
    v_readlane_b32 s85, v64, 18
    v_readlane_b32 s86, v64, 20
    v_readlane_b32 s87, v64, 22
    v_readlane_b32 s88, v64, 24
    v_readlane_b32 s89, v64, 26
    v_readlane_b32 s90, v64, 28
    v_readlane_b32 s91, v64, 30
    v_dot2_f32_bf16 v68, s76, v160, 0
    v_dot2_f32_bf16 v69, s76, v98, 0
    v_dot2_f32_bf16 v70, s76, v161, 0
    v_dot2_f32_bf16 v71, s76, v99, 0
    v_dot2c_f32_bf16 v68, s77, v96
    v_dot2c_f32_bf16 v69, s77, v102
    v_dot2c_f32_bf16 v70, s77, v97
    v_dot2c_f32_bf16 v71, s77, v103
    v_dot2c_f32_bf16 v68, s78, v100
    v_dot2c_f32_bf16 v69, s78, v106
    v_dot2c_f32_bf16 v70, s78, v101
    v_dot2c_f32_bf16 v71, s78, v107
    v_dot2c_f32_bf16 v68, s79, v104
    v_dot2c_f32_bf16 v69, s79, v110
    v_dot2c_f32_bf16 v70, s79, v105
    v_dot2c_f32_bf16 v71, s79, v111
    v_dot2c_f32_bf16 v68, s80, v108
    v_dot2c_f32_bf16 v69, s80, v114
    v_dot2c_f32_bf16 v70, s80, v109
    v_dot2c_f32_bf16 v71, s80, v115
    v_dot2c_f32_bf16 v68, s81, v112
    v_dot2c_f32_bf16 v69, s81, v118
    v_dot2c_f32_bf16 v70, s81, v113
    v_dot2c_f32_bf16 v71, s81, v119
    v_dot2c_f32_bf16 v68, s82, v116
    v_dot2c_f32_bf16 v69, s82, v122
    v_dot2c_f32_bf16 v70, s82, v117
    v_dot2c_f32_bf16 v71, s82, v123
    v_dot2c_f32_bf16 v68, s83, v120
    v_dot2c_f32_bf16 v69, s83, v126
    v_dot2c_f32_bf16 v70, s83, v121
    v_dot2c_f32_bf16 v71, s83, v127
    v_dot2c_f32_bf16 v68, s84, v124
    v_dot2c_f32_bf16 v69, s84, v130
    v_dot2c_f32_bf16 v70, s84, v125
    v_dot2c_f32_bf16 v71, s84, v131
    v_dot2c_f32_bf16 v68, s85, v128
    v_dot2c_f32_bf16 v69, s85, v134
    v_dot2c_f32_bf16 v70, s85, v129
    v_dot2c_f32_bf16 v71, s85, v135
    v_dot2c_f32_bf16 v68, s86, v132
    v_dot2c_f32_bf16 v69, s86, v138
    v_dot2c_f32_bf16 v70, s86, v133
    v_dot2c_f32_bf16 v71, s86, v139
    v_dot2c_f32_bf16 v68, s87, v136
    v_dot2c_f32_bf16 v69, s87, v142
    v_dot2c_f32_bf16 v70, s87, v137
    v_dot2c_f32_bf16 v71, s87, v143
    v_dot2c_f32_bf16 v68, s88, v140
    v_dot2c_f32_bf16 v69, s88, v146
    v_dot2c_f32_bf16 v70, s88, v141
    v_dot2c_f32_bf16 v71, s88, v147
    v_dot2c_f32_bf16 v68, s89, v144
    v_dot2c_f32_bf16 v69, s89, v150
    v_dot2c_f32_bf16 v70, s89, v145
    v_dot2c_f32_bf16 v71, s89, v151
    v_dot2c_f32_bf16 v68, s90, v148
    v_dot2c_f32_bf16 v69, s90, v154
    v_dot2c_f32_bf16 v70, s90, v149
    v_dot2c_f32_bf16 v71, s90, v155
    v_dot2c_f32_bf16 v68, s91, v152
    v_dot2c_f32_bf16 v69, s91, v158
    v_dot2c_f32_bf16 v70, s91, v153
    v_dot2c_f32_bf16 v71, s91, v159
    s_mov_b64 s[14:15], exec
    s_and_b32 exec_hi, exec_hi, s71
    v_bfi_b32 v68, s98, v18, v68
    v_bfi_b32 v69, s98, v18, v69
    v_bfi_b32 v70, s98, v18, v70
    v_bfi_b32 v71, s98, v18, v71
    s_cbranch_execz L_sks1935
    buffer_store_dwordx4 v[68:71], v8, s[44:47], s70 offen sc1
L_sks1935:
    s_mov_b64 exec, s[14:15]
    s_cbranch_execz L_final
    s_cmp_lg_u32 s8, 0
    s_cbranch_scc1 L_wend
    s_cmp_ge_u32 s11, 40
    s_cbranch_scc1 L_wend
L_final:
    s_mov_b32 s52, s38
    s_mov_b32 s53, s39
    s_mov_b32 s54, 1280
    s_mov_b32 s55, 0x20000
    v_lshrrev_b32 v2, 2, v0
    v_mul_u32_u24 v2, 2560, v2
    v_add_u32 v2, v2, v10
    v_lshrrev_b32 v3, 1, v10
    v_lshl_add_u32 v3, v16, 1, v3
    s_add_u32 s62, s69, 442368
    s_add_u32 s63, s62, 40960
    s_add_u32 s64, s62, 81920
    s_add_u32 s65, s62, 122880
    s_lshr_b32 s67, s69, 1
    v_and_b32 v84, s98, v18
    v_and_b32 v85, s98, v18
    v_and_b32 v86, s98, v18
    v_and_b32 v87, s98, v18
    s_cbranch_execz wv_71
    s_waitcnt vmcnt(0)
wv_71:
    s_mov_b32 s61, 0
    s_mov_b64 s[14:15], exec
pl_72:
    s_cbranch_execz pl_72_s
    buffer_load_dwordx4 v[72:75], v2, s[44:47], s62 offen sc1
    buffer_load_dwordx4 v[76:79], v2, s[44:47], s63 offen sc1
    buffer_load_dwordx4 v[80:83], v2, s[44:47], s64 offen sc1
    s_mov_b64 s[76:77], exec
    s_and_b32 exec_lo, exec_lo, 0xffffff
    s_mov_b32 exec_hi, 0
    buffer_load_dwordx4 v[84:87], v2, s[44:47], s65 offen sc1
    s_mov_b64 exec, s[76:77]
    s_waitcnt vmcnt(0)
pl_72_s:
    v_xor_b32 v90, v72, v18
    v_bitop3_b32 v90, v73, v18, v90 bitop3:0xbe
    v_bitop3_b32 v90, v74, v18, v90 bitop3:0xbe
    v_bitop3_b32 v90, v75, v18, v90 bitop3:0xbe
    v_bitop3_b32 v90, v76, v18, v90 bitop3:0xbe
    v_bitop3_b32 v90, v77, v18, v90 bitop3:0xbe
    v_bitop3_b32 v90, v78, v18, v90 bitop3:0xbe
    v_bitop3_b32 v90, v79, v18, v90 bitop3:0xbe
    v_bitop3_b32 v90, v80, v18, v90 bitop3:0xbe
    v_bitop3_b32 v90, v81, v18, v90 bitop3:0xbe
    v_bitop3_b32 v90, v82, v18, v90 bitop3:0xbe
    v_bitop3_b32 v90, v83, v18, v90 bitop3:0xbe
    v_bitop3_b32 v90, v84, v18, v90 bitop3:0xbe
    v_bitop3_b32 v90, v85, v18, v90 bitop3:0xbe
    v_bitop3_b32 v90, v86, v18, v90 bitop3:0xbe
    v_bitop3_b32 v90, v87, v18, v90 bitop3:0xbe
    v_and_b32 v90, s98, v90
    v_cmp_ne_u32 vcc, 0, v90
    s_cbranch_vccz plo_73
    s_mov_b64 exec, vcc
    s_add_u32 s61, s61, 1
    s_cmp_lt_u32 s61, 0x8000
    s_cbranch_scc1 pl_72
plo_73:
    s_mov_b64 exec, s[14:15]
    v_pk_add_f32 v[72:73], v[72:73], v[76:77]
    v_pk_add_f32 v[80:81], v[80:81], v[84:85]
    v_pk_add_f32 v[74:75], v[74:75], v[78:79]
    v_pk_add_f32 v[82:83], v[82:83], v[86:87]
    v_pk_add_f32 v[72:73], v[72:73], v[80:81]
    v_pk_add_f32 v[74:75], v[74:75], v[82:83]
    s_nop 1
    v_permlane32_swap_b32 v72, v74
    v_permlane32_swap_b32 v73, v75
    v_add_f32 v72, v72, v74
    v_add_f32 v73, v73, v75
    s_nop 1
    v_permlane16_swap_b32 v72, v73
    v_add_f32 v72, v72, v73
    s_nop 1
    v_add_f32_dpp v72, v72, v72 row_ror:4 row_mask:0xf bank_mask:0xf
    s_nop 1
    v_add_f32_dpp v72, v72, v72 row_ror:8 row_mask:0xf bank_mask:0xf
    v_fma_f32 v72, v72, v57, v56
    v_cvt_pk_bf16_f32 v72, v72, v72
    s_and_b32 exec_lo, exec_lo, 0x000f000f
    s_and_b32 exec_hi, exec_hi, 0x000f000f
    s_cbranch_execz L_sks2025
    buffer_store_short v72, v3, s[52:55], s67 offen
L_sks2025:
    s_cbranch_execz L_dry_ret
    s_cmp_lg_u32 s11, 0
    s_cbranch_scc1 L_fin2
    s_mov_b64 exec, 1
    v_mov_b32 v6, 0
    buffer_store_dword v18, v6, s[44:47], 0 offen sc1
L_fin2:
    s_branch L_wend
L_stream2:
L_k2_0:
    s_waitcnt vmcnt(5)
    buffer_load_dwordx4 v2, s[48:51], s62 offen nt lds
    s_addk_i32 s62, 0x1000
    s_addk_i32 m0, 0x1000
    s_add_u32 s61, s61, 1
    s_cmp_lt_u32 s61, 18
    s_cbranch_scc1 L_k2_0
    s_load_dword s9, s[42:43], 0
    s_mov_b32 s52, s20
    s_mov_b32 s53, s21
    s_mov_b32 s54, 33554432
    s_mov_b32 s55, 0x20000
    s_mov_b32 s44, s42
    s_mov_b32 s45, s43
    s_mov_b32 s46, 268435456
    s_mov_b32 s47, 0x20000
    s_mov_b32 s8, s3
    s_mov_b32 s10, 0
    s_mov_b32 s11, 0
    s_mov_b32 s98, 0xff
    s_mov_b32 s95, 0
    s_mov_b32 s81, 0
    v_mov_b32 v7, 0
    v_mov_b32 v8, 0
    v_mov_b32 v9, 0
    v_mov_b32 v10, 0
    v_mov_b32 v11, 0
    v_mov_b32 v12, 0
    v_mov_b32 v13, 0
    v_mov_b32 v157, 0
    v_mov_b32 v158, 0
    v_mov_b32 v159, 0
    s_mov_b64 s[14:15], exec
    s_and_b32 exec_lo, exec_lo, 1
    s_mov_b32 exec_hi, 0
    ds_add_u32 v14, v15 offset:24
    s_mov_b64 exec, s[14:15]
L_k2_1:
    s_waitcnt vmcnt(5)
    buffer_load_dwordx4 v2, s[48:51], s62 offen nt lds
    s_addk_i32 s62, 0x1000
    s_addk_i32 m0, 0x1000
    s_add_u32 s61, s61, 1
    s_cmp_lt_u32 s61, 32
    s_cbranch_scc1 L_k2_1
    s_waitcnt vmcnt(5)
    buffer_load_dwordx4 v[128:131], v3, s[52:55], s63 offen nt
    s_addk_i32 s63, 0x1000
    s_waitcnt vmcnt(5)
    buffer_load_dwordx4 v[132:135], v3, s[52:55], s63 offen nt
    s_addk_i32 s63, 0x1000
    s_waitcnt vmcnt(5)
    buffer_load_dwordx4 v[136:139], v3, s[52:55], s63 offen nt
    s_addk_i32 s63, 0x1000
    s_waitcnt vmcnt(5)
    buffer_load_dwordx4 v[140:143], v3, s[52:55], s63 offen nt
    s_addk_i32 s63, 0x1000
    s_waitcnt vmcnt(5)
    s_mov_b64 s[14:15], exec
    s_and_b32 exec_lo, exec_lo, 1
    s_mov_b32 exec_hi, 0
    ds_add_u32 v14, v15 offset:28
    s_mov_b64 exec, s[14:15]
    buffer_load_dwordx4 v[144:147], v3, s[52:55], s63 offen nt
    s_addk_i32 s63, 0x1000
    s_waitcnt vmcnt(5)
    s_mov_b64 s[14:15], exec
    s_and_b32 exec_lo, exec_lo, 1
    s_mov_b32 exec_hi, 0
    ds_add_u32 v14, v15 offset:12
    s_mov_b64 exec, s[14:15]
    buffer_load_dwordx4 v[148:151], v3, s[52:55], s63 offen nt
    s_addk_i32 s63, 0x1000
    s_waitcnt vmcnt(5)
    buffer_load_dwordx4 v[152:155], v3, s[52:55], s63 offen nt
    s_addk_i32 s63, 0x1000
    s_waitcnt vmcnt(5)
    buffer_load_dwordx4 v[156:159], v3, s[52:55], s63 offen nt
    s_addk_i32 s63, 0x1000
    v_perm_b32 v32, v132, v128, s12
    v_perm_b32 v132, v132, v128, s13
    v_perm_b32 v33, v133, v129, s12
    v_perm_b32 v133, v133, v129, s13
    v_perm_b32 v34, v134, v130, s12
    v_perm_b32 v134, v134, v130, s13
    v_perm_b32 v35, v135, v131, s12
    v_perm_b32 v135, v135, v131, s13
    s_waitcnt vmcnt(5)
    buffer_load_dwordx4 v[160:163], v3, s[52:55], s63 offen nt
    s_addk_i32 s63, 0x1000
    s_waitcnt vmcnt(5)
    buffer_load_dwordx4 v[164:167], v3, s[52:55], s63 offen nt
    s_addk_i32 s63, 0x1000
    v_perm_b32 v128, v140, v136, s12
    v_perm_b32 v140, v140, v136, s13
    v_perm_b32 v129, v141, v137, s12
    v_perm_b32 v141, v141, v137, s13
    v_perm_b32 v130, v142, v138, s12
    v_perm_b32 v142, v142, v138, s13
    v_perm_b32 v131, v143, v139, s12
    v_perm_b32 v143, v143, v139, s13
    s_waitcnt vmcnt(5)
    buffer_load_dwordx4 v[168:171], v3, s[52:55], s63 offen nt
    s_addk_i32 s63, 0x1000
    s_waitcnt vmcnt(5)
    buffer_load_dwordx4 v[172:175], v3, s[52:55], s63 offen nt
    s_addk_i32 s63, 0x1000
    v_perm_b32 v136, v148, v144, s12
    v_perm_b32 v148, v148, v144, s13
    v_perm_b32 v137, v149, v145, s12
    v_perm_b32 v149, v149, v145, s13
    v_perm_b32 v138, v150, v146, s12
    v_perm_b32 v150, v150, v146, s13
    v_perm_b32 v139, v151, v147, s12
    v_perm_b32 v151, v151, v147, s13
    s_waitcnt vmcnt(5)
    buffer_load_dwordx4 v[176:179], v3, s[52:55], s63 offen nt
    s_addk_i32 s63, 0x1000
    s_waitcnt vmcnt(5)
    buffer_load_dwordx4 v[180:183], v3, s[52:55], s63 offen nt
    s_addk_i32 s63, 0x1000
    v_perm_b32 v144, v156, v152, s12
    v_perm_b32 v156, v156, v152, s13
    v_perm_b32 v145, v157, v153, s12
    v_perm_b32 v157, v157, v153, s13
    v_perm_b32 v146, v158, v154, s12
    v_perm_b32 v158, v158, v154, s13
    v_perm_b32 v147, v159, v155, s12
    v_perm_b32 v159, v159, v155, s13
    s_waitcnt vmcnt(5)
    buffer_load_dwordx4 v[184:187], v3, s[52:55], s63 offen nt
    s_addk_i32 s63, 0x1000
    s_waitcnt vmcnt(5)
    buffer_load_dwordx4 v[188:191], v3, s[52:55], s63 offen nt
    s_addk_i32 s63, 0x1000
    v_perm_b32 v152, v164, v160, s12
    v_perm_b32 v164, v164, v160, s13
    v_perm_b32 v153, v165, v161, s12
    v_perm_b32 v165, v165, v161, s13
    v_perm_b32 v154, v166, v162, s12
    v_perm_b32 v166, v166, v162, s13
    v_perm_b32 v155, v167, v163, s12
    v_perm_b32 v167, v167, v163, s13
    s_waitcnt vmcnt(5)
    buffer_load_dwordx4 v[192:195], v3, s[52:55], s63 offen nt
    s_addk_i32 s63, 0x1000
    s_waitcnt vmcnt(5)
    buffer_load_dwordx4 v[196:199], v3, s[52:55], s63 offen nt
    s_addk_i32 s63, 0x1000
    v_perm_b32 v160, v172, v168, s12
    v_perm_b32 v172, v172, v168, s13
    v_perm_b32 v161, v173, v169, s12
    v_perm_b32 v173, v173, v169, s13
    v_perm_b32 v162, v174, v170, s12
    v_perm_b32 v174, v174, v170, s13
    v_perm_b32 v163, v175, v171, s12
    v_perm_b32 v175, v175, v171, s13
    s_waitcnt vmcnt(5)
    buffer_load_dwordx4 v[200:203], v3, s[52:55], s63 offen nt
    s_addk_i32 s63, 0x1000
    s_waitcnt vmcnt(5)
    buffer_load_dwordx4 v[204:207], v3, s[52:55], s63 offen nt
    s_addk_i32 s63, 0x1000
    v_perm_b32 v168, v180, v176, s12
    v_perm_b32 v180, v180, v176, s13
    v_perm_b32 v169, v181, v177, s12
    v_perm_b32 v181, v181, v177, s13
    v_perm_b32 v170, v182, v178, s12
    v_perm_b32 v182, v182, v178, s13
    v_perm_b32 v171, v183, v179, s12
    v_perm_b32 v183, v183, v179, s13
    s_waitcnt vmcnt(5)
    buffer_load_dwordx4 v[208:211], v3, s[52:55], s63 offen nt
    s_addk_i32 s63, 0x1000
    s_waitcnt vmcnt(5)
    buffer_load_dwordx4 v[212:215], v3, s[52:55], s63 offen nt
    s_addk_i32 s63, 0x1000
    v_perm_b32 v176, v188, v184, s12
    v_perm_b32 v188, v188, v184, s13
    v_perm_b32 v177, v189, v185, s12
    v_perm_b32 v189, v189, v185, s13
    v_perm_b32 v178, v190, v186, s12
    v_perm_b32 v190, v190, v186, s13
    v_perm_b32 v179, v191, v187, s12
    v_perm_b32 v191, v191, v187, s13
    s_waitcnt vmcnt(5)
    buffer_load_dwordx4 v[216:219], v3, s[52:55], s63 offen nt
    s_addk_i32 s63, 0x1000
    s_waitcnt vmcnt(5)
    buffer_load_dwordx4 v[220:223], v3, s[52:55], s63 offen nt
    s_addk_i32 s63, 0x1000
    v_perm_b32 v184, v196, v192, s12
    v_perm_b32 v196, v196, v192, s13
    v_perm_b32 v185, v197, v193, s12
    v_perm_b32 v197, v197, v193, s13
    v_perm_b32 v186, v198, v194, s12
    v_perm_b32 v198, v198, v194, s13
    v_perm_b32 v187, v199, v195, s12
    v_perm_b32 v199, v199, v195, s13
    s_waitcnt vmcnt(5)
    buffer_load_dwordx4 v[224:227], v3, s[52:55], s63 offen nt
    s_addk_i32 s63, 0x1000
    s_waitcnt vmcnt(5)
    buffer_load_dwordx4 v[228:231], v3, s[52:55], s63 offen nt
    s_addk_i32 s63, 0x1000
    v_perm_b32 v192, v204, v200, s12
    v_perm_b32 v204, v204, v200, s13
    v_perm_b32 v193, v205, v201, s12
    v_perm_b32 v205, v205, v201, s13
    v_perm_b32 v194, v206, v202, s12
    v_perm_b32 v206, v206, v202, s13
    v_perm_b32 v195, v207, v203, s12
    v_perm_b32 v207, v207, v203, s13
    s_waitcnt vmcnt(5)
    buffer_load_dwordx4 v[232:235], v3, s[52:55], s63 offen nt
    s_addk_i32 s63, 0x1000
    s_waitcnt vmcnt(5)
    buffer_load_dwordx4 v[236:239], v3, s[52:55], s63 offen nt
    s_addk_i32 s63, 0x1000
    v_perm_b32 v200, v212, v208, s12
    v_perm_b32 v212, v212, v208, s13
    v_perm_b32 v201, v213, v209, s12
    v_perm_b32 v213, v213, v209, s13
    v_perm_b32 v202, v214, v210, s12
    v_perm_b32 v214, v214, v210, s13
    v_perm_b32 v203, v215, v211, s12
    v_perm_b32 v215, v215, v211, s13
    s_waitcnt vmcnt(5)
    s_mov_b64 s[14:15], exec
    s_and_b32 exec_lo, exec_lo, 1
    s_mov_b32 exec_hi, 0
    ds_add_u32 v14, v15 offset:32
    s_mov_b64 exec, s[14:15]
    buffer_load_dwordx4 v[240:243], v3, s[52:55], s63 offen nt
    s_addk_i32 s63, 0x1000
    s_waitcnt vmcnt(5)
    buffer_load_dwordx4 v[244:247], v3, s[52:55], s63 offen nt
    s_addk_i32 s63, 0x1000
    v_perm_b32 v208, v220, v216, s12
    v_perm_b32 v220, v220, v216, s13
    v_perm_b32 v209, v221, v217, s12
    v_perm_b32 v221, v221, v217, s13
    v_perm_b32 v210, v222, v218, s12
    v_perm_b32 v222, v222, v218, s13
    v_perm_b32 v211, v223, v219, s12
    v_perm_b32 v223, v223, v219, s13
    s_waitcnt vmcnt(5)
    buffer_load_dwordx4 v[248:251], v3, s[52:55], s63 offen nt
    s_addk_i32 s63, 0x1000
    s_waitcnt vmcnt(5)
    buffer_load_dwordx4 v[252:255], v3, s[52:55], s63 offen nt
    v_perm_b32 v216, v228, v224, s12
    v_perm_b32 v228, v228, v224, s13
    v_perm_b32 v217, v229, v225, s12
    v_perm_b32 v229, v229, v225, s13
    v_perm_b32 v218, v230, v226, s12
    v_perm_b32 v230, v230, v226, s13
    v_perm_b32 v219, v231, v227, s12
    v_perm_b32 v231, v231, v227, s13
    s_mov_b64 s[14:15], exec
    s_and_b32 exec_lo, exec_lo, 1
    s_mov_b32 exec_hi, 0
    ds_add_u32 v14, v15 offset:84
    s_mov_b64 exec, s[14:15]
    s_setprio 3
    s_waitcnt lgkmcnt(0)
    s_add_u32 s9, s9, 1640531527
    v_mov_b32 v18, s9
    v_lshlrev_b32 v7, 6, v6
    v_add_u32 v7, 135680, v7
    v_lshlrev_b32 v8, 5, v5
    v_lshl_add_u32 v8, v4, 3, v8
    s_lshl_b32 s60, s3, 9
    s_add_u32 s60, s60, 137216
    v_add_u32 v8, s60, v8
    v_lshlrev_b32 v9, 4, v0
    v_add_u32 v10, 137216, v9
    v_mov_b32 v11, 135440
    v_mov_b32 v12, 0
    v_lshlrev_b32 v13, 7, v0
L_pv:
    s_lshl_b32 s60, s6, 3
    s_add_u32 s60, s60, s7
    s_lshl_b32 s63, s60, 4
    s_add_u32 s63, s63, 393216
    s_lshl_b32 s60, s60, 9
    s_add_u32 s62, s60, 262144
    v_mov_b32 v36, 0
    v_mov_b32 v37, 0
    v_mov_b32 v38, 0
    v_mov_b32 v39, 0
    v_mov_b32 v40, 0
    v_mov_b32 v41, 0
    v_mov_b32 v42, 0
    v_mov_b32 v43, 0
    s_mov_b32 s61, 0
sp_1:
    ds_read_b32 v44, v14 offset:16
    s_waitcnt lgkmcnt(0)
    s_cbranch_execz spo_2
    v_readfirstlane_b32 s60, v44
    s_cmp_ge_u32 s60, 4
    s_cbranch_scc1 spo_2
    s_sleep 1
    s_add_u32 s61, s61, 1
    s_cmp_lt_u32 s61, 0x40000
    s_cbranch_scc1 sp_1
spo_2:
    ds_read_b128 v[48:51], v7 offset:0
    ds_read_b128 v[52:55], v7 offset:16
    ds_read_b128 v[56:59], v7 offset:32
    ds_read_b128 v[60:63], v7 offset:48
    s_waitcnt lgkmcnt(0)
    v_dot2c_f32_bf16 v36, v32, v48
    v_dot2c_f32_bf16 v37, v132, v48
    v_dot2c_f32_bf16 v38, v33, v48
    v_dot2c_f32_bf16 v39, v133, v48
    v_dot2c_f32_bf16 v40, v34, v48
    v_dot2c_f32_bf16 v41, v134, v48
    v_dot2c_f32_bf16 v42, v35, v48
    v_dot2c_f32_bf16 v43, v135, v48
    v_dot2c_f32_bf16 v36, v128, v49
    v_dot2c_f32_bf16 v37, v140, v49
    v_dot2c_f32_bf16 v38, v129, v49
    v_dot2c_f32_bf16 v39, v141, v49
    v_dot2c_f32_bf16 v40, v130, v49
    v_dot2c_f32_bf16 v41, v142, v49
    v_dot2c_f32_bf16 v42, v131, v49
    v_dot2c_f32_bf16 v43, v143, v49
    v_dot2c_f32_bf16 v36, v136, v50
    v_dot2c_f32_bf16 v37, v148, v50
    v_dot2c_f32_bf16 v38, v137, v50
    v_dot2c_f32_bf16 v39, v149, v50
    v_dot2c_f32_bf16 v40, v138, v50
    v_dot2c_f32_bf16 v41, v150, v50
    v_dot2c_f32_bf16 v42, v139, v50
    v_dot2c_f32_bf16 v43, v151, v50
    v_dot2c_f32_bf16 v36, v144, v51
    v_dot2c_f32_bf16 v37, v156, v51
    v_dot2c_f32_bf16 v38, v145, v51
    v_dot2c_f32_bf16 v39, v157, v51
    v_dot2c_f32_bf16 v40, v146, v51
    v_dot2c_f32_bf16 v41, v158, v51
    v_dot2c_f32_bf16 v42, v147, v51
    v_dot2c_f32_bf16 v43, v159, v51
    v_dot2c_f32_bf16 v36, v152, v52
    v_dot2c_f32_bf16 v37, v164, v52
    v_dot2c_f32_bf16 v38, v153, v52
    v_dot2c_f32_bf16 v39, v165, v52
    v_dot2c_f32_bf16 v40, v154, v52
    v_dot2c_f32_bf16 v41, v166, v52
    v_dot2c_f32_bf16 v42, v155, v52
    v_dot2c_f32_bf16 v43, v167, v52
    v_dot2c_f32_bf16 v36, v160, v53
    v_dot2c_f32_bf16 v37, v172, v53
    v_dot2c_f32_bf16 v38, v161, v53
    v_dot2c_f32_bf16 v39, v173, v53
    v_dot2c_f32_bf16 v40, v162, v53
    v_dot2c_f32_bf16 v41, v174, v53
    v_dot2c_f32_bf16 v42, v163, v53
    v_dot2c_f32_bf16 v43, v175, v53
    v_dot2c_f32_bf16 v36, v168, v54
    v_dot2c_f32_bf16 v37, v180, v54
    v_dot2c_f32_bf16 v38, v169, v54
    v_dot2c_f32_bf16 v39, v181, v54
    v_dot2c_f32_bf16 v40, v170, v54
    v_dot2c_f32_bf16 v41, v182, v54
    v_dot2c_f32_bf16 v42, v171, v54
    v_dot2c_f32_bf16 v43, v183, v54
    v_dot2c_f32_bf16 v36, v176, v55
    v_dot2c_f32_bf16 v37, v188, v55
    v_dot2c_f32_bf16 v38, v177, v55
    v_dot2c_f32_bf16 v39, v189, v55
    v_dot2c_f32_bf16 v40, v178, v55
    v_dot2c_f32_bf16 v41, v190, v55
    v_dot2c_f32_bf16 v42, v179, v55
    v_dot2c_f32_bf16 v43, v191, v55
    v_dot2c_f32_bf16 v36, v184, v56
    v_dot2c_f32_bf16 v37, v196, v56
    v_dot2c_f32_bf16 v38, v185, v56
    v_dot2c_f32_bf16 v39, v197, v56
    v_dot2c_f32_bf16 v40, v186, v56
    v_dot2c_f32_bf16 v41, v198, v56
    v_dot2c_f32_bf16 v42, v187, v56
    v_dot2c_f32_bf16 v43, v199, v56
    v_dot2c_f32_bf16 v36, v192, v57
    v_dot2c_f32_bf16 v37, v204, v57
    v_dot2c_f32_bf16 v38, v193, v57
    v_dot2c_f32_bf16 v39, v205, v57
    v_dot2c_f32_bf16 v40, v194, v57
    v_dot2c_f32_bf16 v41, v206, v57
    v_dot2c_f32_bf16 v42, v195, v57
    v_dot2c_f32_bf16 v43, v207, v57
    v_dot2c_f32_bf16 v36, v200, v58
    v_dot2c_f32_bf16 v37, v212, v58
    v_dot2c_f32_bf16 v38, v201, v58
    v_dot2c_f32_bf16 v39, v213, v58
    v_dot2c_f32_bf16 v40, v202, v58
    v_dot2c_f32_bf16 v41, v214, v58
    v_dot2c_f32_bf16 v42, v203, v58
    v_dot2c_f32_bf16 v43, v215, v58
    v_dot2c_f32_bf16 v36, v208, v59
    v_dot2c_f32_bf16 v37, v220, v59
    v_dot2c_f32_bf16 v38, v209, v59
    v_dot2c_f32_bf16 v39, v221, v59
    v_dot2c_f32_bf16 v40, v210, v59
    v_dot2c_f32_bf16 v41, v222, v59
    v_dot2c_f32_bf16 v42, v211, v59
    v_dot2c_f32_bf16 v43, v223, v59
    v_dot2c_f32_bf16 v36, v216, v60
    v_dot2c_f32_bf16 v37, v228, v60
    v_dot2c_f32_bf16 v38, v217, v60
    v_dot2c_f32_bf16 v39, v229, v60
    v_dot2c_f32_bf16 v40, v218, v60
    v_dot2c_f32_bf16 v41, v230, v60
    v_dot2c_f32_bf16 v42, v219, v60
    v_dot2c_f32_bf16 v43, v231, v60
    s_cbranch_execz wv_3
    s_waitcnt vmcnt(4)
wv_3:
    v_perm_b32 v224, v236, v232, s12
    v_perm_b32 v236, v236, v232, s13
    v_perm_b32 v225, v237, v233, s12
    v_perm_b32 v237, v237, v233, s13
    v_perm_b32 v226, v238, v234, s12
    v_perm_b32 v238, v238, v234, s13
    v_perm_b32 v227, v239, v235, s12
    v_perm_b32 v239, v239, v235, s13
    v_dot2c_f32_bf16 v36, v224, v61
    v_dot2c_f32_bf16 v37, v236, v61
    v_dot2c_f32_bf16 v38, v225, v61
    v_dot2c_f32_bf16 v39, v237, v61
    v_dot2c_f32_bf16 v40, v226, v61
    v_dot2c_f32_bf16 v41, v238, v61
    v_dot2c_f32_bf16 v42, v227, v61
    v_dot2c_f32_bf16 v43, v239, v61
    s_cbranch_execz wv_4
    s_waitcnt vmcnt(2)
wv_4:
    v_perm_b32 v232, v244, v240, s12
    v_perm_b32 v244, v244, v240, s13
    v_perm_b32 v233, v245, v241, s12
    v_perm_b32 v245, v245, v241, s13
    v_perm_b32 v234, v246, v242, s12
    v_perm_b32 v246, v246, v242, s13
    v_perm_b32 v235, v247, v243, s12
    v_perm_b32 v247, v247, v243, s13
    v_dot2c_f32_bf16 v36, v232, v62
    v_dot2c_f32_bf16 v37, v244, v62
    v_dot2c_f32_bf16 v38, v233, v62
    v_dot2c_f32_bf16 v39, v245, v62
    v_dot2c_f32_bf16 v40, v234, v62
    v_dot2c_f32_bf16 v41, v246, v62
    v_dot2c_f32_bf16 v42, v235, v62
    v_dot2c_f32_bf16 v43, v247, v62
    s_cbranch_execz wv_5
    s_waitcnt vmcnt(0)
wv_5:
    v_perm_b32 v240, v252, v248, s12
    v_perm_b32 v252, v252, v248, s13
    v_perm_b32 v241, v253, v249, s12
    v_perm_b32 v253, v253, v249, s13
    v_perm_b32 v242, v254, v250, s12
    v_perm_b32 v254, v254, v250, s13
    v_perm_b32 v243, v255, v251, s12
    v_perm_b32 v255, v255, v251, s13
    v_dot2c_f32_bf16 v36, v240, v63
    v_dot2c_f32_bf16 v37, v252, v63
    v_dot2c_f32_bf16 v38, v241, v63
    v_dot2c_f32_bf16 v39, v253, v63
    v_dot2c_f32_bf16 v40, v242, v63
    v_dot2c_f32_bf16 v41, v254, v63
    v_dot2c_f32_bf16 v42, v243, v63
    v_dot2c_f32_bf16 v43, v255, v63
    v_permlane32_swap_b32 v36, v40
    v_permlane32_swap_b32 v37, v41
    v_permlane32_swap_b32 v38, v42
    v_permlane32_swap_b32 v39, v43
    v_add_f32 v36, v36, v40
    v_add_f32 v37, v37, v41
    v_add_f32 v38, v38, v42
    v_add_f32 v39, v39, v43
    s_nop 0
    v_permlane16_swap_b32 v36, v38
    v_permlane16_swap_b32 v37, v39
    v_add_f32 v36, v36, v38
    v_add_f32 v37, v37, v39
    ds_write_b64 v8, v[36:37]
    s_mov_b64 s[14:15], exec
    s_and_b32 exec_lo, exec_lo, 1
    s_mov_b32 exec_hi, 0
    ds_add_rtn_u32 v44, v14, v15 offset:36
    s_mov_b64 exec, s[14:15]
    s_waitcnt lgkmcnt(0)
    s_cbranch_execz la_6
    v_readfirstlane_b32 s60, v44
    s_cmp_lg_u32 s60, 3
    s_cbranch_scc1 L_send
la_6:
    s_mov_b64 s[76:77], exec
    s_mov_b32 exec_hi, 0
    ds_read_b128 v[48:51], v10 offset:0
    ds_read_b128 v[52:55], v10 offset:512
    ds_read_b128 v[56:59], v10 offset:1024
    ds_read_b128 v[60:63], v10 offset:1536
    ds_read_b128 v[64:67], v11
    ds_read_b32 v68, v11 offset:16
    s_waitcnt lgkmcnt(2)
    v_pk_add_f32 v[48:49], v[48:49], v[52:53]
    v_pk_add_f32 v[56:57], v[56:57], v[60:61]
    v_pk_add_f32 v[50:51], v[50:51], v[54:55]
    v_pk_add_f32 v[58:59], v[58:59], v[62:63]
    v_pk_add_f32 v[48:49], v[48:49], v[56:57]
    v_pk_add_f32 v[50:51], v[50:51], v[58:59]
    v_bfi_b32 v48, s98, v18, v48
    v_bfi_b32 v49, s98, v18, v49
    v_bfi_b32 v50, s98, v18, v50
    v_bfi_b32 v51, s98, v18, v51
    s_cbranch_execz L_sks2554
    buffer_store_dwordx4 v[48:51], v9, s[44:47], s62 offen sc1
L_sks2554:
    s_and_b32 exec_lo, exec_lo, 1
    s_waitcnt lgkmcnt(0)
    v_add_f32 v64, v64, v65
    v_add_f32 v66, v66, v67
    v_add_f32 v69, v64, v66
    v_bfi_b32 v68, s98, v18, v68
    v_bfi_b32 v69, s98, v18, v69
    v_mov_b32 v70, v68
    v_mov_b32 v71, v69
    s_cbranch_execz L_sks2564
    buffer_store_dwordx4 v[68:71], v12, s[44:47], s63 offen sc1
L_sks2564:
    s_mov_b64 exec, s[76:77]
L_send:
    s_cbranch_execz L_dry_ret
    s_mov_b32 s48, s28
    s_mov_b32 s49, s29
    s_mov_b32 s50, 2211840
    s_mov_b32 s51, 0x20000
    s_mov_b32 s52, s30
    s_mov_b32 s53, s31
    s_mov_b32 s54, 2211840
    s_mov_b32 s55, 0x20000
    s_mov_b32 s56, s32
    s_mov_b32 s57, s33
    s_mov_b32 s58, 2211840
    s_mov_b32 s59, 0x20000
    v_lshlrev_b32 v10, 6, v0
    v_mov_b32 v13, 0x7fffffff
    v_lshrrev_b32 v11, 3, v0
    v_mul_u32_u24 v11, 3456, v11
    v_bfe_u32 v12, v0, 1, 2
    v_lshlrev_b32 v12, 3, v12
    v_add_u32 v12, s4, v12
    v_lshl_add_u32 v11, v12, 7, v11
    v_and_b32 v9, 1, v0
    v_lshl_add_u32 v11, v9, 6, v11
    v_cmp_gt_u32 vcc, 27, v12
    s_nop 1
    v_cndmask_b32 v11, v13, v11, vcc
    v_cmp_gt_u32 vcc, 40, v0
    s_nop 1
    v_cndmask_b32 v11, v13, v11, vcc
    v_cndmask_b32 v10, v13, v10, vcc
    s_lshl_b32 s60, s5, 2
    s_add_u32 s60, s60, s3
    s_mul_i32 s78, s60, 17280
    s_lshr_b32 s61, s60, 5
    s_lshl_b32 s61, s61, 3
    s_add_u32 s61, s61, s4
    s_lshl_b32 s61, s61, 5
    s_and_b32 s60, s60, 31
    s_add_u32 s61, s61, s60
    s_mul_i32 s77, s61, 2560
    buffer_load_dword v76, v11, s[48:51], s78 offen
    buffer_load_dword v77, v11, s[52:55], s78 offen
    buffer_load_dword v78, v10, s[56:59], s77 offen
    s_sub_u32 s60, s5, 24
    s_lshr_b32 s61, s60, 1
    s_lshl_b32 s61, s61, 3
    s_add_u32 s61, s61, s4
    s_cmp_ge_u32 s60, 8
    s_cbranch_scc1 L_noG1
    s_cmp_lt_u32 s61, 27
    s_cbranch_scc1 L_G0
L_noG1:
L_noG:
    s_waitcnt vmcnt(0)
    s_mov_b64 s[14:15], exec
    s_and_b32 exec_lo, exec_lo, 1
    s_mov_b32 exec_hi, 0
    ds_add_u32 v14, v15 offset:72
    s_mov_b64 exec, s[14:15]
    s_branch L_wend
L_G0:
    s_lshl_b32 s11, s61, 1
    s_and_b32 s60, s60, 1
    s_add_u32 s11, s11, s60
    s_waitcnt vmcnt(0)
    s_mul_i32 s60, s8, 160
    v_lshrrev_b32 v2, 2, v0
    v_mul_u32_u24 v2, 10, v2
    v_add_u32 v2, s60, v2
    v_mul_u32_u24 v3, 3456, v2
    v_and_b32 v4, 3, v0
    v_lshl_add_u32 v3, v4, 4, v3
    s_lshl_b32 s61, s11, 6
    buffer_load_dwordx4 v[96:99], v3, s[48:51], s61 offen
    buffer_load_dwordx4 v[136:139], v3, s[52:55], s61 offen
    s_addk_i32 s61, 3456
    buffer_load_dwordx4 v[100:103], v3, s[48:51], s61 offen
    buffer_load_dwordx4 v[140:143], v3, s[52:55], s61 offen
    s_addk_i32 s61, 3456
    buffer_load_dwordx4 v[104:107], v3, s[48:51], s61 offen
    buffer_load_dwordx4 v[144:147], v3, s[52:55], s61 offen
    s_addk_i32 s61, 3456
    buffer_load_dwordx4 v[108:111], v3, s[48:51], s61 offen
    buffer_load_dwordx4 v[148:151], v3, s[52:55], s61 offen
    s_addk_i32 s61, 3456
    buffer_load_dwordx4 v[112:115], v3, s[48:51], s61 offen
    buffer_load_dwordx4 v[152:155], v3, s[52:55], s61 offen
    s_addk_i32 s61, 3456
    buffer_load_dwordx4 v[116:119], v3, s[48:51], s61 offen
    buffer_load_dwordx4 v[156:159], v3, s[52:55], s61 offen
    s_addk_i32 s61, 3456
    buffer_load_dwordx4 v[120:123], v3, s[48:51], s61 offen
    buffer_load_dwordx4 v[160:163], v3, s[52:55], s61 offen
    s_addk_i32 s61, 3456
    buffer_load_dwordx4 v[124:127], v3, s[48:51], s61 offen
    buffer_load_dwordx4 v[164:167], v3, s[52:55], s61 offen
    s_addk_i32 s61, 3456
    buffer_load_dwordx4 v[128:131], v3, s[48:51], s61 offen
    buffer_load_dwordx4 v[168:171], v3, s[52:55], s61 offen
    s_addk_i32 s61, 3456
    buffer_load_dwordx4 v[132:135], v3, s[48:51], s61 offen
    buffer_load_dwordx4 v[172:175], v3, s[52:55], s61 offen
    s_mov_b64 s[14:15], exec
    s_and_b32 exec_lo, exec_lo, 1
    s_mov_b32 exec_hi, 0
    ds_add_u32 v14, v15 offset:80
    s_mov_b64 exec, s[14:15]
L_Gp:
    v_and_b32 v5, 7, v0
    v_lshlrev_b32 v6, 4, v5
    s_mul_i32 s65, s8, 640
    v_lshrrev_b32 v16, 4, v0
    v_mul_u32_u24 v1, 5, v16
    v_add_u32 v11, 0, v1
    v_lshrrev_b32 v12, 2, v11
    v_and_b32 v11, 3, v11
    v_lshl_add_u32 v11, v12, 5, v11
    v_lshl_add_u32 v11, v5, 2, v11
    s_mul_i32 s60, s8, 320
    s_add_u32 s60, s60, 141312
    v_lshlrev_b32 v12, 1, v11
    v_add_u32 v245, s60, v12
    v_lshlrev_b32 v12, 2, v11
    v_add_u32 v25, s65, v12
    v_add_u32 v250, 143872, v25
    v_add_u32 v11, 1, v1
    v_lshrrev_b32 v12, 2, v11
    v_and_b32 v11, 3, v11
    v_lshl_add_u32 v11, v12, 5, v11
    v_lshl_add_u32 v11, v5, 2, v11
    s_mul_i32 s60, s8, 320
    s_add_u32 s60, s60, 141312
    v_lshlrev_b32 v12, 1, v11
    v_add_u32 v246, s60, v12
    v_lshlrev_b32 v12, 2, v11
    v_add_u32 v26, s65, v12
    v_add_u32 v251, 143872, v26
    v_add_u32 v11, 2, v1
    v_lshrrev_b32 v12, 2, v11
    v_and_b32 v11, 3, v11
    v_lshl_add_u32 v11, v12, 5, v11
    v_lshl_add_u32 v11, v5, 2, v11
    s_mul_i32 s60, s8, 320
    s_add_u32 s60, s60, 141312
    v_lshlrev_b32 v12, 1, v11
    v_add_u32 v247, s60, v12
    v_lshlrev_b32 v12, 2, v11
    v_add_u32 v27, s65, v12
    v_add_u32 v252, 143872, v27
    v_add_u32 v11, 3, v1
    v_lshrrev_b32 v12, 2, v11
    v_and_b32 v11, 3, v11
    v_lshl_add_u32 v11, v12, 5, v11
    v_lshl_add_u32 v11, v5, 2, v11
    s_mul_i32 s60, s8, 320
    s_add_u32 s60, s60, 141312
    v_lshlrev_b32 v12, 1, v11
    v_add_u32 v248, s60, v12
    v_lshlrev_b32 v12, 2, v11
    v_add_u32 v28, s65, v12
    v_add_u32 v253, 143872, v28
    v_add_u32 v11, 4, v1
    v_lshrrev_b32 v12, 2, v11
    v_and_b32 v11, 3, v11
    v_lshl_add_u32 v11, v12, 5, v11
    v_lshl_add_u32 v11, v5, 2, v11
    s_mul_i32 s60, s8, 320
    s_add_u32 s60, s60, 141312
    v_lshlrev_b32 v12, 1, v11
    v_add_u32 v249, s60, v12
    v_lshlrev_b32 v12, 2, v11
    v_add_u32 v29, s65, v12
    v_add_u32 v254, 143872, v29
    v_lshrrev_b32 v2, 2, v0
    v_mul_u32_u24 v2, 20, v2
    s_mul_i32 s60, s8, 320
    s_add_u32 s60, s60, 141312
    v_add_u32 v2, s60, v2
    v_lshrrev_b32 v3, 3, v0
    v_mul_u32_u24 v3, 2560, v3
    v_add_u32 v3, v3, v6
    s_add_u32 s87, s65, 401408
    s_lshl_b32 s60, s8, 8
    s_add_u32 s60, s60, 142848
    v_lshrrev_b32 v5, 1, v16
    v_lshlrev_b32 v5, 7, v5
    v_lshl_add_u32 v5, v4, 5, v5
    v_and_b32 v7, 1, v16
    v_lshl_add_u32 v5, v7, 4, v5
    v_add_u32 v5, s60, v5
    s_lshl_b32 s60, s8, 3
    s_add_u32 s60, s60, 142592
    v_lshrrev_b32 v12, 5, v0
    v_lshlrev_b32 v12, 2, v12
    v_add_u32 v12, s60, v12
    v_mov_b32 v13, 142592
    s_mov_b32 s61, 0
sp_7:
    ds_read_b32 v60, v14 offset:76
    s_waitcnt lgkmcnt(0)
    s_cbranch_execz spo_8
    v_readfirstlane_b32 s60, v60
    s_cmp_ge_u32 s60, 4
    s_cbranch_scc1 spo_8
    s_sleep 1
    s_add_u32 s61, s61, 1
    s_cmp_lt_u32 s61, 0x40000
    s_cbranch_scc1 sp_7
spo_8:
    ds_read_b32 v20, v25 offset:0
    ds_read_b32 v21, v26 offset:0
    ds_read_b32 v22, v27 offset:0
    ds_read_b32 v23, v28 offset:0
    ds_read_b32 v24, v29 offset:0
    ds_read_b32 v45, v25 offset:2560
    ds_read_b32 v46, v26 offset:2560
    ds_read_b32 v47, v27 offset:2560
    ds_read_b32 v48, v28 offset:2560
    ds_read_b32 v49, v29 offset:2560
    ds_read_b32 v40, v25 offset:5120
    ds_read_b32 v41, v26 offset:5120
    ds_read_b32 v42, v27 offset:5120
    ds_read_b32 v43, v28 offset:5120
    ds_read_b32 v44, v29 offset:5120
    ds_read_b32 v50, v25 offset:10240
    ds_read_b32 v51, v26 offset:10240
    ds_read_b32 v52, v27 offset:10240
    ds_read_b32 v53, v28 offset:10240
    ds_read_b32 v54, v29 offset:10240
    s_waitcnt lgkmcnt(0)
    v_add_f32 v40, 1.0, v40
    v_cvt_pk_bf16_f32 v90, v40, v40
    v_lshlrev_b32 v40, 16, v90
    v_add_f32 v41, 1.0, v41
    v_cvt_pk_bf16_f32 v90, v41, v41
    v_lshlrev_b32 v41, 16, v90
    v_add_f32 v42, 1.0, v42
    v_cvt_pk_bf16_f32 v90, v42, v42
    v_lshlrev_b32 v42, 16, v90
    v_add_f32 v43, 1.0, v43
    v_cvt_pk_bf16_f32 v90, v43, v43
    v_lshlrev_b32 v43, 16, v90
    v_add_f32 v44, 1.0, v44
    v_cvt_pk_bf16_f32 v90, v44, v44
    v_lshlrev_b32 v44, 16, v90
    s_cbranch_execz wv_9
    s_waitcnt vmcnt(0)
wv_9:
    v_perm_b32 v92, v100, v96, s12
    v_perm_b32 v100, v100, v96, s13
    v_perm_b32 v93, v101, v97, s12
    v_perm_b32 v101, v101, v97, s13
    v_perm_b32 v94, v102, v98, s12
    v_perm_b32 v102, v102, v98, s13
    v_perm_b32 v95, v103, v99, s12
    v_perm_b32 v103, v103, v99, s13
    v_perm_b32 v96, v108, v104, s12
    v_perm_b32 v108, v108, v104, s13
    v_perm_b32 v97, v109, v105, s12
    v_perm_b32 v109, v109, v105, s13
    v_perm_b32 v98, v110, v106, s12
    v_perm_b32 v110, v110, v106, s13
    v_perm_b32 v99, v111, v107, s12
    v_perm_b32 v111, v111, v107, s13
    v_perm_b32 v104, v116, v112, s12
    v_perm_b32 v116, v116, v112, s13
    v_perm_b32 v105, v117, v113, s12
    v_perm_b32 v117, v117, v113, s13
    v_perm_b32 v106, v118, v114, s12
    v_perm_b32 v118, v118, v114, s13
    v_perm_b32 v107, v119, v115, s12
    v_perm_b32 v119, v119, v115, s13
    v_perm_b32 v112, v124, v120, s12
    v_perm_b32 v124, v124, v120, s13
    v_perm_b32 v113, v125, v121, s12
    v_perm_b32 v125, v125, v121, s13
    v_perm_b32 v114, v126, v122, s12
    v_perm_b32 v126, v126, v122, s13
    v_perm_b32 v115, v127, v123, s12
    v_perm_b32 v127, v127, v123, s13
    v_perm_b32 v120, v132, v128, s12
    v_perm_b32 v132, v132, v128, s13
    v_perm_b32 v121, v133, v129, s12
    v_perm_b32 v133, v133, v129, s13
    v_perm_b32 v122, v134, v130, s12
    v_perm_b32 v134, v134, v130, s13
    v_perm_b32 v123, v135, v131, s12
    v_perm_b32 v135, v135, v131, s13
    v_perm_b32 v128, v140, v136, s12
    v_perm_b32 v140, v140, v136, s13
    v_perm_b32 v129, v141, v137, s12
    v_perm_b32 v141, v141, v137, s13
    v_perm_b32 v130, v142, v138, s12
    v_perm_b32 v142, v142, v138, s13
    v_perm_b32 v131, v143, v139, s12
    v_perm_b32 v143, v143, v139, s13
    v_perm_b32 v136, v148, v144, s12
    v_perm_b32 v148, v148, v144, s13
    v_perm_b32 v137, v149, v145, s12
    v_perm_b32 v149, v149, v145, s13
    v_perm_b32 v138, v150, v146, s12
    v_perm_b32 v150, v150, v146, s13
    v_perm_b32 v139, v151, v147, s12
    v_perm_b32 v151, v151, v147, s13
    v_perm_b32 v144, v156, v152, s12
    v_perm_b32 v156, v156, v152, s13
    v_perm_b32 v145, v157, v153, s12
    v_perm_b32 v157, v157, v153, s13
    v_perm_b32 v146, v158, v154, s12
    v_perm_b32 v158, v158, v154, s13
    v_perm_b32 v147, v159, v155, s12
    v_perm_b32 v159, v159, v155, s13
    v_perm_b32 v152, v164, v160, s12
    v_perm_b32 v164, v164, v160, s13
    v_perm_b32 v153, v165, v161, s12
    v_perm_b32 v165, v165, v161, s13
    v_perm_b32 v154, v166, v162, s12
    v_perm_b32 v166, v166, v162, s13
    v_perm_b32 v155, v167, v163, s12
    v_perm_b32 v167, v167, v163, s13
    v_perm_b32 v160, v172, v168, s12
    v_perm_b32 v172, v172, v168, s13
    v_perm_b32 v161, v173, v169, s12
    v_perm_b32 v173, v173, v169, s13
    v_perm_b32 v162, v174, v170, s12
    v_perm_b32 v174, v174, v170, s13
    v_perm_b32 v163, v175, v171, s12
    v_perm_b32 v175, v175, v171, s13
    v_subrev_u32 v6, 142848, v5
    v_cvt_pk_bf16_f32 v85, v40, v40
    v_cvt_pk_bf16_f32 v86, v41, v41
    v_cvt_pk_bf16_f32 v87, v42, v42
    v_cvt_pk_bf16_f32 v88, v43, v43
    v_cvt_pk_bf16_f32 v89, v44, v44
    ds_write_b16 v245, v85
    ds_write_b16 v246, v86
    ds_write_b16 v247, v87
    ds_write_b16 v248, v88
    ds_write_b16 v249, v89
    ds_read2_b32 v[80:81], v2 offset0:0 offset1:1
    ds_read2_b32 v[82:83], v2 offset0:2 offset1:3
    ds_read_b32 v84, v2 offset:16
    s_waitcnt lgkmcnt(0)
    v_dot2_f32_bf16 v64, v92, v80, 0
    v_dot2_f32_bf16 v65, v100, v80, 0
    v_dot2_f32_bf16 v66, v93, v80, 0
    v_dot2_f32_bf16 v67, v101, v80, 0
    v_dot2_f32_bf16 v68, v94, v80, 0
    v_dot2_f32_bf16 v69, v102, v80, 0
    v_dot2_f32_bf16 v70, v95, v80, 0
    v_dot2_f32_bf16 v71, v103, v80, 0
    v_dot2_f32_bf16 v72, v128, v80, 0
    v_dot2_f32_bf16 v73, v140, v80, 0
    v_dot2_f32_bf16 v74, v129, v80, 0
    v_dot2_f32_bf16 v75, v141, v80, 0
    v_dot2_f32_bf16 v76, v130, v80, 0
    v_dot2_f32_bf16 v77, v142, v80, 0
    v_dot2_f32_bf16 v78, v131, v80, 0
    v_dot2_f32_bf16 v79, v143, v80, 0
    v_dot2c_f32_bf16 v64, v96, v81
    v_dot2c_f32_bf16 v65, v108, v81
    v_dot2c_f32_bf16 v66, v97, v81
    v_dot2c_f32_bf16 v67, v109, v81
    v_dot2c_f32_bf16 v68, v98, v81
    v_dot2c_f32_bf16 v69, v110, v81
    v_dot2c_f32_bf16 v70, v99, v81
    v_dot2c_f32_bf16 v71, v111, v81
    v_dot2c_f32_bf16 v72, v136, v81
    v_dot2c_f32_bf16 v73, v148, v81
    v_dot2c_f32_bf16 v74, v137, v81
    v_dot2c_f32_bf16 v75, v149, v81
    v_dot2c_f32_bf16 v76, v138, v81
    v_dot2c_f32_bf16 v77, v150, v81
    v_dot2c_f32_bf16 v78, v139, v81
    v_dot2c_f32_bf16 v79, v151, v81
    v_dot2c_f32_bf16 v64, v104, v82
    v_dot2c_f32_bf16 v65, v116, v82
    v_dot2c_f32_bf16 v66, v105, v82
    v_dot2c_f32_bf16 v67, v117, v82
    v_dot2c_f32_bf16 v68, v106, v82
    v_dot2c_f32_bf16 v69, v118, v82
    v_dot2c_f32_bf16 v70, v107, v82
    v_dot2c_f32_bf16 v71, v119, v82
    v_dot2c_f32_bf16 v72, v144, v82
    v_dot2c_f32_bf16 v73, v156, v82
    v_dot2c_f32_bf16 v74, v145, v82
    v_dot2c_f32_bf16 v75, v157, v82
    v_dot2c_f32_bf16 v76, v146, v82
    v_dot2c_f32_bf16 v77, v158, v82
    v_dot2c_f32_bf16 v78, v147, v82
    v_dot2c_f32_bf16 v79, v159, v82
    v_dot2c_f32_bf16 v64, v112, v83
    v_dot2c_f32_bf16 v65, v124, v83
    v_dot2c_f32_bf16 v66, v113, v83
    v_dot2c_f32_bf16 v67, v125, v83
    v_dot2c_f32_bf16 v68, v114, v83
    v_dot2c_f32_bf16 v69, v126, v83
    v_dot2c_f32_bf16 v70, v115, v83
    v_dot2c_f32_bf16 v71, v127, v83
    v_dot2c_f32_bf16 v72, v152, v83
    v_dot2c_f32_bf16 v73, v164, v83
    v_dot2c_f32_bf16 v74, v153, v83
    v_dot2c_f32_bf16 v75, v165, v83
    v_dot2c_f32_bf16 v76, v154, v83
    v_dot2c_f32_bf16 v77, v166, v83
    v_dot2c_f32_bf16 v78, v155, v83
    v_dot2c_f32_bf16 v79, v167, v83
    v_dot2c_f32_bf16 v64, v120, v84
    v_dot2c_f32_bf16 v65, v132, v84
    v_dot2c_f32_bf16 v66, v121, v84
    v_dot2c_f32_bf16 v67, v133, v84
    v_dot2c_f32_bf16 v68, v122, v84
    v_dot2c_f32_bf16 v69, v134, v84
    v_dot2c_f32_bf16 v70, v123, v84
    v_dot2c_f32_bf16 v71, v135, v84
    v_dot2c_f32_bf16 v72, v160, v84
    v_dot2c_f32_bf16 v73, v172, v84
    v_dot2c_f32_bf16 v74, v161, v84
    v_dot2c_f32_bf16 v75, v173, v84
    v_dot2c_f32_bf16 v76, v162, v84
    v_dot2c_f32_bf16 v77, v174, v84
    v_dot2c_f32_bf16 v78, v163, v84
    v_dot2c_f32_bf16 v79, v175, v84
    v_permlane32_swap_b32 v64, v72
    v_permlane32_swap_b32 v65, v73
    v_permlane32_swap_b32 v66, v74
    v_permlane32_swap_b32 v67, v75
    v_permlane32_swap_b32 v68, v76
    v_permlane32_swap_b32 v69, v77
    v_permlane32_swap_b32 v70, v78
    v_permlane32_swap_b32 v71, v79
    v_pk_add_f32 v[64:65], v[64:65], v[72:73]
    v_pk_add_f32 v[66:67], v[66:67], v[74:75]
    v_pk_add_f32 v[68:69], v[68:69], v[76:77]
    v_pk_add_f32 v[70:71], v[70:71], v[78:79]
    s_nop 0
    v_permlane16_swap_b32 v64, v68
    v_permlane16_swap_b32 v65, v69
    v_permlane16_swap_b32 v66, v70
    v_permlane16_swap_b32 v67, v71
    v_pk_add_f32 v[64:65], v[64:65], v[68:69]
    v_pk_add_f32 v[66:67], v[66:67], v[70:71]
    s_nop 0
    v_add_f32_dpp v64, v64, v64 row_ror:4 row_mask:0xf bank_mask:0xf
    v_add_f32_dpp v65, v65, v65 row_ror:4 row_mask:0xf bank_mask:0xf
    v_add_f32_dpp v66, v66, v66 row_ror:4 row_mask:0xf bank_mask:0xf
    v_add_f32_dpp v67, v67, v67 row_ror:4 row_mask:0xf bank_mask:0xf
    v_add_f32_dpp v64, v64, v64 row_ror:8 row_mask:0xf bank_mask:0xf
    v_add_f32_dpp v65, v65, v65 row_ror:8 row_mask:0xf bank_mask:0xf
    v_add_f32_dpp v66, v66, v66 row_ror:8 row_mask:0xf bank_mask:0xf
    v_add_f32_dpp v67, v67, v67 row_ror:8 row_mask:0xf bank_mask:0xf
    ds_write_b128 v6, v[64:67] offset:16384
    v_cvt_pk_bf16_f32 v85, v45, v45
    v_cvt_pk_bf16_f32 v86, v46, v46
    v_cvt_pk_bf16_f32 v87, v47, v47
    v_cvt_pk_bf16_f32 v88, v48, v48
    v_cvt_pk_bf16_f32 v89, v49, v49
    ds_write_b16 v245, v85
    ds_write_b16 v246, v86
    ds_write_b16 v247, v87
    ds_write_b16 v248, v88
    ds_write_b16 v249, v89
    ds_read2_b32 v[80:81], v2 offset0:0 offset1:1
    ds_read2_b32 v[82:83], v2 offset0:2 offset1:3
    ds_read_b32 v84, v2 offset:16
    s_waitcnt lgkmcnt(0)
    v_dot2_f32_bf16 v64, v92, v80, 0
    v_dot2_f32_bf16 v65, v100, v80, 0
    v_dot2_f32_bf16 v66, v93, v80, 0
    v_dot2_f32_bf16 v67, v101, v80, 0
    v_dot2_f32_bf16 v68, v94, v80, 0
    v_dot2_f32_bf16 v69, v102, v80, 0
    v_dot2_f32_bf16 v70, v95, v80, 0
    v_dot2_f32_bf16 v71, v103, v80, 0
    v_dot2_f32_bf16 v72, v128, v80, 0
    v_dot2_f32_bf16 v73, v140, v80, 0
    v_dot2_f32_bf16 v74, v129, v80, 0
    v_dot2_f32_bf16 v75, v141, v80, 0
    v_dot2_f32_bf16 v76, v130, v80, 0
    v_dot2_f32_bf16 v77, v142, v80, 0
    v_dot2_f32_bf16 v78, v131, v80, 0
    v_dot2_f32_bf16 v79, v143, v80, 0
    v_dot2c_f32_bf16 v64, v96, v81
    v_dot2c_f32_bf16 v65, v108, v81
    v_dot2c_f32_bf16 v66, v97, v81
    v_dot2c_f32_bf16 v67, v109, v81
    v_dot2c_f32_bf16 v68, v98, v81
    v_dot2c_f32_bf16 v69, v110, v81
    v_dot2c_f32_bf16 v70, v99, v81
    v_dot2c_f32_bf16 v71, v111, v81
    v_dot2c_f32_bf16 v72, v136, v81
    v_dot2c_f32_bf16 v73, v148, v81
    v_dot2c_f32_bf16 v74, v137, v81
    v_dot2c_f32_bf16 v75, v149, v81
    v_dot2c_f32_bf16 v76, v138, v81
    v_dot2c_f32_bf16 v77, v150, v81
    v_dot2c_f32_bf16 v78, v139, v81
    v_dot2c_f32_bf16 v79, v151, v81
    v_dot2c_f32_bf16 v64, v104, v82
    v_dot2c_f32_bf16 v65, v116, v82
    v_dot2c_f32_bf16 v66, v105, v82
    v_dot2c_f32_bf16 v67, v117, v82
    v_dot2c_f32_bf16 v68, v106, v82
    v_dot2c_f32_bf16 v69, v118, v82
    v_dot2c_f32_bf16 v70, v107, v82
    v_dot2c_f32_bf16 v71, v119, v82
    v_dot2c_f32_bf16 v72, v144, v82
    v_dot2c_f32_bf16 v73, v156, v82
    v_dot2c_f32_bf16 v74, v145, v82
    v_dot2c_f32_bf16 v75, v157, v82
    v_dot2c_f32_bf16 v76, v146, v82
    v_dot2c_f32_bf16 v77, v158, v82
    v_dot2c_f32_bf16 v78, v147, v82
    v_dot2c_f32_bf16 v79, v159, v82
    v_dot2c_f32_bf16 v64, v112, v83
    v_dot2c_f32_bf16 v65, v124, v83
    v_dot2c_f32_bf16 v66, v113, v83
    v_dot2c_f32_bf16 v67, v125, v83
    v_dot2c_f32_bf16 v68, v114, v83
    v_dot2c_f32_bf16 v69, v126, v83
    v_dot2c_f32_bf16 v70, v115, v83
    v_dot2c_f32_bf16 v71, v127, v83
    v_dot2c_f32_bf16 v72, v152, v83
    v_dot2c_f32_bf16 v73, v164, v83
    v_dot2c_f32_bf16 v74, v153, v83
    v_dot2c_f32_bf16 v75, v165, v83
    v_dot2c_f32_bf16 v76, v154, v83
    v_dot2c_f32_bf16 v77, v166, v83
    v_dot2c_f32_bf16 v78, v155, v83
    v_dot2c_f32_bf16 v79, v167, v83
    v_dot2c_f32_bf16 v64, v120, v84
    v_dot2c_f32_bf16 v65, v132, v84
    v_dot2c_f32_bf16 v66, v121, v84
    v_dot2c_f32_bf16 v67, v133, v84
    v_dot2c_f32_bf16 v68, v122, v84
    v_dot2c_f32_bf16 v69, v134, v84
    v_dot2c_f32_bf16 v70, v123, v84
    v_dot2c_f32_bf16 v71, v135, v84
    v_dot2c_f32_bf16 v72, v160, v84
    v_dot2c_f32_bf16 v73, v172, v84
    v_dot2c_f32_bf16 v74, v161, v84
    v_dot2c_f32_bf16 v75, v173, v84
    v_dot2c_f32_bf16 v76, v162, v84
    v_dot2c_f32_bf16 v77, v174, v84
    v_dot2c_f32_bf16 v78, v163, v84
    v_dot2c_f32_bf16 v79, v175, v84
    v_permlane32_swap_b32 v64, v72
    v_permlane32_swap_b32 v65, v73
    v_permlane32_swap_b32 v66, v74
    v_permlane32_swap_b32 v67, v75
    v_permlane32_swap_b32 v68, v76
    v_permlane32_swap_b32 v69, v77
    v_permlane32_swap_b32 v70, v78
    v_permlane32_swap_b32 v71, v79
    v_pk_add_f32 v[64:65], v[64:65], v[72:73]
    v_pk_add_f32 v[66:67], v[66:67], v[74:75]
    v_pk_add_f32 v[68:69], v[68:69], v[76:77]
    v_pk_add_f32 v[70:71], v[70:71], v[78:79]
    s_nop 0
    v_permlane16_swap_b32 v64, v68
    v_permlane16_swap_b32 v65, v69
    v_permlane16_swap_b32 v66, v70
    v_permlane16_swap_b32 v67, v71
    v_pk_add_f32 v[64:65], v[64:65], v[68:69]
    v_pk_add_f32 v[66:67], v[66:67], v[70:71]
    s_nop 0
    v_add_f32_dpp v64, v64, v64 row_ror:4 row_mask:0xf bank_mask:0xf
    v_add_f32_dpp v65, v65, v65 row_ror:4 row_mask:0xf bank_mask:0xf
    v_add_f32_dpp v66, v66, v66 row_ror:4 row_mask:0xf bank_mask:0xf
    v_add_f32_dpp v67, v67, v67 row_ror:4 row_mask:0xf bank_mask:0xf
    v_add_f32_dpp v64, v64, v64 row_ror:8 row_mask:0xf bank_mask:0xf
    v_add_f32_dpp v65, v65, v65 row_ror:8 row_mask:0xf bank_mask:0xf
    v_add_f32_dpp v66, v66, v66 row_ror:8 row_mask:0xf bank_mask:0xf
    v_add_f32_dpp v67, v67, v67 row_ror:8 row_mask:0xf bank_mask:0xf
    ds_write_b128 v6, v[64:67] offset:17408
    s_mov_b64 s[14:15], exec
    s_and_b32 exec_lo, exec_lo, 1
    s_mov_b32 exec_hi, 0
    ds_add_u32 v14, v15 offset:44
    s_mov_b64 exec, s[14:15]
    s_cbranch_execz L_dry_ret
L_Gtail:
    s_mov_b32 s61, 0
    s_mov_b64 s[78:79], exec
    s_and_b32 exec_lo, exec_lo, 0x1010101
    s_and_b32 exec_hi, exec_hi, 0x1010101
pw_10:
    s_cbranch_execz pwo_11
    buffer_load_dwordx4 v[60:63], v3, s[44:47], s87 offen sc1
    s_waitcnt vmcnt(0)
    v_xor_b32 v90, v60, v18
    v_bitop3_b32 v90, v61, v18, v90 bitop3:0xbe
    v_bitop3_b32 v90, v62, v18, v90 bitop3:0xbe
    v_bitop3_b32 v90, v63, v18, v90 bitop3:0xbe
    v_and_b32 v90, s98, v90
    v_cmp_ne_u32 vcc, 0, v90
    s_cmp_eq_u64 vcc, exec
    s_cbranch_scc0 pwo_11
    s_sleep 4
    s_add_u32 s61, s61, 1
    s_cmp_lt_u32 s61, 0x8000
    s_cbranch_scc1 pw_10
pwo_11:
    s_mov_b64 exec, s[78:79]
    s_mov_b32 s61, 0
    s_mov_b64 s[14:15], exec
pl_12:
    s_cbranch_execz pl_12_s
    buffer_load_dwordx4 v[60:63], v3, s[44:47], s87 offen offset:0 sc1
    buffer_load_dwordx4 v[64:67], v3, s[44:47], s87 offen offset:128 sc1
    buffer_load_dwordx4 v[68:71], v3, s[44:47], s87 offen offset:256 sc1
    buffer_load_dwordx4 v[72:75], v3, s[44:47], s87 offen offset:384 sc1
    buffer_load_dwordx4 v[76:79], v3, s[44:47], s87 offen offset:512 sc1
    s_waitcnt vmcnt(0)
pl_12_s:
    v_xor_b32 v90, v60, v18
    v_bitop3_b32 v90, v61, v18, v90 bitop3:0xbe
    v_bitop3_b32 v90, v62, v18, v90 bitop3:0xbe
    v_bitop3_b32 v90, v63, v18, v90 bitop3:0xbe
    v_bitop3_b32 v90, v64, v18, v90 bitop3:0xbe
    v_bitop3_b32 v90, v65, v18, v90 bitop3:0xbe
    v_bitop3_b32 v90, v66, v18, v90 bitop3:0xbe
    v_bitop3_b32 v90, v67, v18, v90 bitop3:0xbe
    v_bitop3_b32 v90, v68, v18, v90 bitop3:0xbe
    v_bitop3_b32 v90, v69, v18, v90 bitop3:0xbe
    v_bitop3_b32 v90, v70, v18, v90 bitop3:0xbe
    v_bitop3_b32 v90, v71, v18, v90 bitop3:0xbe
    v_bitop3_b32 v90, v72, v18, v90 bitop3:0xbe
    v_bitop3_b32 v90, v73, v18, v90 bitop3:0xbe
    v_bitop3_b32 v90, v74, v18, v90 bitop3:0xbe
    v_bitop3_b32 v90, v75, v18, v90 bitop3:0xbe
    v_bitop3_b32 v90, v76, v18, v90 bitop3:0xbe
    v_bitop3_b32 v90, v77, v18, v90 bitop3:0xbe
    v_bitop3_b32 v90, v78, v18, v90 bitop3:0xbe
    v_bitop3_b32 v90, v79, v18, v90 bitop3:0xbe
    v_and_b32 v90, s98, v90
    v_cmp_ne_u32 vcc, 0, v90
    s_cbranch_vccz plo_13
    s_mov_b64 exec, vcc
    s_add_u32 s61, s61, 1
    s_cmp_lt_u32 s61, 0x8000
    s_cbranch_scc1 pl_12
plo_13:
    s_mov_b64 exec, s[14:15]
    v_permlane32_swap_b32 v60, v70
    v_permlane32_swap_b32 v61, v71
    v_permlane32_swap_b32 v62, v72
    v_permlane32_swap_b32 v63, v73
    v_permlane32_swap_b32 v64, v74
    v_permlane32_swap_b32 v65, v75
    v_permlane32_swap_b32 v66, v76
    v_permlane32_swap_b32 v67, v77
    v_permlane32_swap_b32 v68, v78
    v_permlane32_swap_b32 v69, v79
    v_pk_add_f32 v[60:61], v[60:61], v[70:71]
    v_pk_add_f32 v[62:63], v[62:63], v[72:73]
    v_pk_add_f32 v[64:65], v[64:65], v[74:75]
    v_pk_add_f32 v[66:67], v[66:67], v[76:77]
    v_pk_add_f32 v[68:69], v[68:69], v[78:79]
    v_permlane16_swap_b32 v60, v65
    v_permlane16_swap_b32 v61, v66
    v_permlane16_swap_b32 v62, v67
    v_permlane16_swap_b32 v63, v68
    v_permlane16_swap_b32 v64, v69
    v_add_f32 v60, v60, v65
    v_add_f32 v61, v61, v66
    v_add_f32 v62, v62, v67
    v_add_f32 v63, v63, v68
    v_add_f32 v64, v64, v69
    v_add_f32_dpp v60, v60, v60 row_ror:8 row_mask:0xf bank_mask:0xf
    v_add_f32_dpp v61, v61, v61 row_ror:8 row_mask:0xf bank_mask:0xf
    v_add_f32_dpp v62, v62, v62 row_ror:8 row_mask:0xf bank_mask:0xf
    v_add_f32_dpp v63, v63, v63 row_ror:8 row_mask:0xf bank_mask:0xf
    v_add_f32_dpp v64, v64, v64 row_ror:8 row_mask:0xf bank_mask:0xf
    v_fma_f32 v30, v60, v20, v50
    v_fma_f32 v31, v61, v21, v51
    v_fma_f32 v32, v62, v22, v52
    v_fma_f32 v33, v63, v23, v53
    v_fma_f32 v34, v64, v24, v54
    v_mul_f32 v60, v30, v40
    v_mul_f32 v61, v31, v41
    v_mul_f32 v62, v32, v42
    v_mul_f32 v63, v33, v43
    v_mul_f32 v64, v34, v44
    v_cvt_pk_bf16_f32 v85, v60, v60
    v_cvt_pk_bf16_f32 v86, v61, v61
    v_cvt_pk_bf16_f32 v87, v62, v62
    v_cvt_pk_bf16_f32 v88, v63, v63
    v_cvt_pk_bf16_f32 v89, v64, v64
    ds_write_b16 v245, v85
    ds_write_b16 v246, v86
    ds_write_b16 v247, v87
    ds_write_b16 v248, v88
    ds_write_b16 v249, v89
    ds_read2_b32 v[80:81], v2 offset0:0 offset1:1
    ds_read2_b32 v[82:83], v2 offset0:2 offset1:3
    ds_read_b32 v84, v2 offset:16
    ds_write_b32 v250, v30
    ds_write_b32 v251, v31
    ds_write_b32 v252, v32
    ds_write_b32 v253, v33
    ds_write_b32 v254, v34
    v_add_f32 v36, v30, v31
    v_mul_f32 v37, v30, v30
    v_add_f32 v38, v32, v33
    v_fmac_f32 v37, v31, v31
    v_add_f32 v36, v36, v34
    v_fmac_f32 v37, v32, v32
    v_add_f32 v36, v36, v38
    v_fmac_f32 v37, v33, v33
    v_fmac_f32 v37, v34, v34
    s_nop 1
    v_permlane32_swap_b32 v36, v37
    v_add_f32 v36, v36, v37
    s_nop 1
    v_add_f32_dpp v36, v36, v36 quad_perm:[1,0,3,2] row_mask:0xf bank_mask:0xf
    s_nop 1
    v_add_f32_dpp v36, v36, v36 quad_perm:[2,3,0,1] row_mask:0xf bank_mask:0xf
    s_nop 1
    v_add_f32_dpp v36, v36, v36 row_half_mirror row_mask:0xf bank_mask:0xf
    v_mov_b32 v37, v36
    s_nop 1
    v_permlane16_swap_b32 v37, v36
    v_add_f32 v36, v36, v37
    ds_write_b32 v12, v36
    s_waitcnt lgkmcnt(1)
    v_dot2_f32_bf16 v64, v92, v80, 0
    v_dot2_f32_bf16 v65, v100, v80, 0
    v_dot2_f32_bf16 v66, v93, v80, 0
    v_dot2_f32_bf16 v67, v101, v80, 0
    v_dot2_f32_bf16 v68, v94, v80, 0
    v_dot2_f32_bf16 v69, v102, v80, 0
    v_dot2_f32_bf16 v70, v95, v80, 0
    v_dot2_f32_bf16 v71, v103, v80, 0
    v_dot2_f32_bf16 v72, v128, v80, 0
    v_dot2_f32_bf16 v73, v140, v80, 0
    v_dot2_f32_bf16 v74, v129, v80, 0
    v_dot2_f32_bf16 v75, v141, v80, 0
    v_dot2_f32_bf16 v76, v130, v80, 0
    v_dot2_f32_bf16 v77, v142, v80, 0
    v_dot2_f32_bf16 v78, v131, v80, 0
    v_dot2_f32_bf16 v79, v143, v80, 0
    v_dot2c_f32_bf16 v64, v96, v81
    v_dot2c_f32_bf16 v65, v108, v81
    v_dot2c_f32_bf16 v66, v97, v81
    v_dot2c_f32_bf16 v67, v109, v81
    v_dot2c_f32_bf16 v68, v98, v81
    v_dot2c_f32_bf16 v69, v110, v81
    v_dot2c_f32_bf16 v70, v99, v81
    v_dot2c_f32_bf16 v71, v111, v81
    v_dot2c_f32_bf16 v72, v136, v81
    v_dot2c_f32_bf16 v73, v148, v81
    v_dot2c_f32_bf16 v74, v137, v81
    v_dot2c_f32_bf16 v75, v149, v81
    v_dot2c_f32_bf16 v76, v138, v81
    v_dot2c_f32_bf16 v77, v150, v81
    v_dot2c_f32_bf16 v78, v139, v81
    v_dot2c_f32_bf16 v79, v151, v81
    v_dot2c_f32_bf16 v64, v104, v82
    v_dot2c_f32_bf16 v65, v116, v82
    v_dot2c_f32_bf16 v66, v105, v82
    v_dot2c_f32_bf16 v67, v117, v82
    v_dot2c_f32_bf16 v68, v106, v82
    v_dot2c_f32_bf16 v69, v118, v82
    v_dot2c_f32_bf16 v70, v107, v82
    v_dot2c_f32_bf16 v71, v119, v82
    v_dot2c_f32_bf16 v72, v144, v82
    v_dot2c_f32_bf16 v73, v156, v82
    v_dot2c_f32_bf16 v74, v145, v82
    v_dot2c_f32_bf16 v75, v157, v82
    v_dot2c_f32_bf16 v76, v146, v82
    v_dot2c_f32_bf16 v77, v158, v82
    v_dot2c_f32_bf16 v78, v147, v82
    v_dot2c_f32_bf16 v79, v159, v82
    v_dot2c_f32_bf16 v64, v112, v83
    v_dot2c_f32_bf16 v65, v124, v83
    v_dot2c_f32_bf16 v66, v113, v83
    v_dot2c_f32_bf16 v67, v125, v83
    v_dot2c_f32_bf16 v68, v114, v83
    v_dot2c_f32_bf16 v69, v126, v83
    v_dot2c_f32_bf16 v70, v115, v83
    v_dot2c_f32_bf16 v71, v127, v83
    v_dot2c_f32_bf16 v72, v152, v83
    v_dot2c_f32_bf16 v73, v164, v83
    v_dot2c_f32_bf16 v74, v153, v83
    v_dot2c_f32_bf16 v75, v165, v83
    v_dot2c_f32_bf16 v76, v154, v83
    v_dot2c_f32_bf16 v77, v166, v83
    v_dot2c_f32_bf16 v78, v155, v83
    v_dot2c_f32_bf16 v79, v167, v83
    v_dot2c_f32_bf16 v64, v120, v84
    v_dot2c_f32_bf16 v65, v132, v84
    v_dot2c_f32_bf16 v66, v121, v84
    v_dot2c_f32_bf16 v67, v133, v84
    v_dot2c_f32_bf16 v68, v122, v84
    v_dot2c_f32_bf16 v69, v134, v84
    v_dot2c_f32_bf16 v70, v123, v84
    v_dot2c_f32_bf16 v71, v135, v84
    v_dot2c_f32_bf16 v72, v160, v84
    v_dot2c_f32_bf16 v73, v172, v84
    v_dot2c_f32_bf16 v74, v161, v84
    v_dot2c_f32_bf16 v75, v173, v84
    v_dot2c_f32_bf16 v76, v162, v84
    v_dot2c_f32_bf16 v77, v174, v84
    v_dot2c_f32_bf16 v78, v163, v84
    v_dot2c_f32_bf16 v79, v175, v84
    v_permlane32_swap_b32 v64, v72
    v_permlane32_swap_b32 v65, v73
    v_permlane32_swap_b32 v66, v74
    v_permlane32_swap_b32 v67, v75
    v_permlane32_swap_b32 v68, v76
    v_permlane32_swap_b32 v69, v77
    v_permlane32_swap_b32 v70, v78
    v_permlane32_swap_b32 v71, v79
    v_pk_add_f32 v[64:65], v[64:65], v[72:73]
    v_pk_add_f32 v[66:67], v[66:67], v[74:75]
    v_pk_add_f32 v[68:69], v[68:69], v[76:77]
    v_pk_add_f32 v[70:71], v[70:71], v[78:79]
    s_nop 0
    v_permlane16_swap_b32 v64, v68
    v_permlane16_swap_b32 v65, v69
    v_permlane16_swap_b32 v66, v70
    v_permlane16_swap_b32 v67, v71
    v_pk_add_f32 v[64:65], v[64:65], v[68:69]
    v_pk_add_f32 v[66:67], v[66:67], v[70:71]
    s_nop 0
    v_add_f32_dpp v64, v64, v64 row_ror:4 row_mask:0xf bank_mask:0xf
    v_add_f32_dpp v65, v65, v65 row_ror:4 row_mask:0xf bank_mask:0xf
    v_add_f32_dpp v66, v66, v66 row_ror:4 row_mask:0xf bank_mask:0xf
    v_add_f32_dpp v67, v67, v67 row_ror:4 row_mask:0xf bank_mask:0xf
    v_add_f32_dpp v64, v64, v64 row_ror:8 row_mask:0xf bank_mask:0xf
    v_add_f32_dpp v65, v65, v65 row_ror:8 row_mask:0xf bank_mask:0xf
    v_add_f32_dpp v66, v66, v66 row_ror:8 row_mask:0xf bank_mask:0xf
    v_add_f32_dpp v67, v67, v67 row_ror:8 row_mask:0xf bank_mask:0xf
    ds_write_b128 v5, v[64:67]
    s_waitcnt lgkmcnt(0)
    s_cbranch_execz L_dry_ret
    s_barrier
L_wend:
    s_cbranch_execz L_dry_ret
    s_endpgm
L_end:
    s_endpgm
.section .rodata,"a"
.p2align 6
.amdhsa_kernel adaLN_cond__gqa_block_cached__glu_gated_geglu__decode_kernel
  .amdhsa_next_free_vgpr 256
  .amdhsa_next_free_sgpr 100
  .amdhsa_accum_offset 256
  .amdhsa_group_segment_fixed_size 0
  .amdhsa_kernarg_size 112
  .amdhsa_user_sgpr_count 2
  .amdhsa_user_sgpr_kernarg_segment_ptr 1
  .amdhsa_system_sgpr_workgroup_id_x 1
  .amdhsa_float_denorm_mode_32 3
.end_amdhsa_kernel
```
